```python
import torch

def _softmax(x, axis=-1):
    return torch.softmax(x, dim=axis)
def _gelu(x):
    return torch.nn.functional.gelu(x, approximate="tanh")
def _silu(x):
    return torch.nn.functional.silu(x)
def _sigmoid(x):
    return torch.sigmoid(x)
def _layernorm(x, axis=-1, eps=1e-5):
    m = x.mean(dim=axis, keepdim=True)
    v = x.var(dim=axis, keepdim=True, unbiased=False)
    return (x - m) / torch.sqrt(v + eps)
def _scatter_add(tgt, idx, src, axis=0):
    return tgt.clone().index_add_(axis, idx, src)
def _segment_sum(src, seg, n):
    out = torch.zeros((n,) + src.shape[1:], dtype=src.dtype)
    return out.index_add_(0, seg, src)
def _pad(x, pw):
    flat = tuple(v for pair in reversed(pw) for v in pair)
    return torch.nn.functional.pad(x, flat)

kernel_name = 'concat_heads__sliding_block_cached__compressed_kv_cla__decode'

def setup_inputs():

    _w = (lambda a: (lambda t: t.to(torch.bfloat16) if t.is_floating_point() else t)(torch.as_tensor(a)))
    def _A_setup():
        B, Sq, D = 2, 1, 512
        Hq, Hkv, Sk, Dh = 32, 32, 8192, 128
        assert Hq % Hkv == 0, (Hq, Hkv)
        return {
            "x": _w((lambda *s: torch.randn(*s, dtype=torch.bfloat16) * 1.6)(B, Sq, D)),
            "k_cache": _w((lambda *s: torch.randn(*s, dtype=torch.bfloat16) * 1.6)(B, Hkv, Sk, Dh)),
            "v_cache": _w((lambda *s: torch.randn(*s, dtype=torch.bfloat16) * 0.05)(B, Hkv, Sk, Dh)),
            "wq": _w((lambda *s: torch.randn(*s, dtype=torch.bfloat16) * 1.6)(D, Hq * Dh) * (D ** -0.5)),
            "wo": _w((lambda *s: torch.randn(*s, dtype=torch.bfloat16) * 0.05)(Hq * Dh, D) * ((Hq * Dh) ** -0.5)),
        }
    _A_in = _A_setup()

    def _B_setup():
        B, H, Sq, Sk, D, M = 2, 32, 1, 8192, 128, 512
        Dc = 4 * D
        return {
            "x": _w((lambda *s: torch.randn(*s, dtype=torch.bfloat16) * 3.2)(B, Sq, M)),
            "c_kv": _w((lambda *s: torch.randn(*s, dtype=torch.bfloat16) * 0.1)(B, Sk, Dc)),
            "w_q": _w((lambda *s: torch.randn(*s, dtype=torch.bfloat16) * 6.4)(M, H, D) * (M ** -0.5)),
            "w_uk": _w((lambda *s: torch.randn(*s, dtype=torch.bfloat16) * 6.4)(Dc, H, D) * (Dc ** -0.5)),
            "w_uv": _w((lambda *s: torch.randn(*s, dtype=torch.bfloat16) * 0.1)(Dc, H, D) * (Dc ** -0.5)),
            "w_o": _w((lambda *s: torch.randn(*s, dtype=torch.bfloat16) * 0.1)(H, D, M) * ((H * D) ** -0.5)),
        }
    _B_in = _B_setup()

    return {
        "A_x": _A_in["x"],
        "A_k_cache": _A_in["k_cache"],
        "A_v_cache": _A_in["v_cache"],
        "A_wq": _A_in["wq"],
        "A_wo": _A_in["wo"],
        "B_x": _B_in["x"],
        "B_c_kv": _B_in["c_kv"],
        "B_w_q": _B_in["w_q"],
        "B_w_uk": _B_in["w_uk"],
        "B_w_uv": _B_in["w_uv"],
        "B_w_o": _B_in["w_o"],
    }

def reference(A_x, A_k_cache, A_v_cache, A_wq, A_wo, B_x, B_c_kv, B_w_q, B_w_uk, B_w_uv, B_w_o):
    def _A_ref(x, k_cache, v_cache, wq, wo):
        B, Sq, D = x.shape
        Hq, Dh = 32, 128
        Hkv, Sk = k_cache.shape[1], k_cache.shape[2]
        W = min(4096, max(256, Sk // 4))
        rep = Hq // Hkv
        q = (lambda x, *d: x.permute(*d))((x @ wq).reshape(B, Sq, Hq, Dh), 0, 2, 1, 3)
        k = (lambda x, n, axis: torch.repeat_interleave(x, n, dim=axis))(k_cache[:, :, Sk - W:, :], rep, axis=1)
        v = (lambda x, n, axis: torch.repeat_interleave(x, n, dim=axis))(v_cache[:, :, Sk - W:, :], rep, axis=1)
        scores = torch.einsum("bhqd,bhkd->bhqk", q, k) * (Dh ** -0.5)
        p = _softmax(scores, axis=-1)
        o = torch.einsum("bhqk,bhkd->bhqd", p, v)
        return (lambda x, *d: x.permute(*d))(o, 0, 2, 1, 3).reshape(B, Sq, Hq * Dh) @ wo

    def _B_ref(x, c_kv, w_q, w_uk, w_uv, w_o):
        B, Sq, M = x.shape[0], x.shape[1], x.shape[2]
        Sk = c_kv.shape[1]
        H, D = w_q.shape[1], w_q.shape[2]
        q = torch.einsum("bqm,mhd->bhqd", x, w_q)
        k = torch.einsum("bkc,chd->bhkd", c_kv, w_uk)
        v = torch.einsum("bkc,chd->bhkd", c_kv, w_uv)
        scores = torch.einsum("bhqd,bhkd->bhqk", q, k) * (D ** -0.5)
        off = Sk - Sq
        qi = torch.arange(Sq)[:, None]
        kj = torch.arange(Sk)[None, :]
        cmask = kj <= (qi + off)
        scores = torch.where(cmask[None, None], scores, -1e9)
        p = _softmax(scores, axis=-1)
        ctx = torch.einsum("bhqk,bhkd->bhqd", p, v)
        return torch.einsum("bhqd,hdm->bqm", ctx, w_o)

    a = _A_ref(A_x, A_k_cache, A_v_cache, A_wq, A_wo)
    b = _B_ref(B_x, B_c_kv, B_w_q, B_w_uk, B_w_uv, B_w_o)
    return torch.concatenate([a, b], axis=-1)
```

```asm
; @launch grid=(256,1,1) block=(512,1,1) lds=163840
.amdgcn_target "amdgcn-amd-amdhsa--gfx950"
.text
.globl concat_heads__sliding_block_cached__compressed_kv_cla__decode_kernel
.p2align 8
.type concat_heads__sliding_block_cached__compressed_kv_cla__decode_kernel,@function
concat_heads__sliding_block_cached__compressed_kv_cla__decode_kernel:
    s_load_dwordx8 s[64:71], s[0:1], 48
    v_lshrrev_b32 v8, 6, v0
    s_cmp_ge_u32 s2, 256
    s_cbranch_scc1 L_end
    v_readfirstlane_b32 s3, v8
    s_lshr_b32 s4, s2, 3
    s_add_u32 s5, s2, s4
    s_mul_i32 s5, s5, 3
    s_bfe_u32 s6, s5, 0x10002
    s_and_b32 s7, s5, 3
    v_and_b32 v1, 15, v0
    v_bfe_u32 v2, v0, 4, 2
    s_mul_i32 s38, s3, 17
    s_bfe_u32 s38, s38, 0x40002
    s_mov_b32 s33, 0x24d7d111
    s_cmp_eq_u32 s7, 2
    s_cmov_b32 s33, 0x32d85512
    s_cselect_b32 s63, 1, 0
    s_xor_b32 s63, s63, s4
    s_cmp_eq_u32 s7, 3
    s_cmov_b32 s33, 0x886de4a
    s_cselect_b32 s38, s38, 0
    s_cselect_b32 s10, 24, 22
    s_lshl_b32 s10, 1, s10
    s_cmp_eq_u32 s7, 1
    s_cselect_b32 s36, 2, 0
    s_or_b32 s42, s36, s6
    s_lshl_b32 s40, s3, s33
    s_lshr_b32 s33, s33, 5
    s_lshl_b32 s36, s63, s33
    s_add_u32 s40, s40, s36
    s_lshr_b32 s33, s33, 5
    s_lshl_b32 s36, s42, s33
    s_add_u32 s40, s40, s36
    s_lshr_b32 s33, s33, 5
    s_lshl_b32 s41, 1, s33
    s_lshr_b32 s33, s33, 5
    s_bfe_u32 s36, s33, 0x20005
    v_mul_u32_u24 v11, s36, v2
    v_xor_b32 v10, s38, v1
    v_lshlrev_b32 v9, s33, v2
    v_xor_b32 v10, v10, v11
    s_lshr_b32 s33, s33, 2
    s_and_b32 s38, s33, 0x60
    s_and_b32 s39, s33, 0x80
    v_lshl_add_u32 v3, v10, 4, v9
    s_lshl_b32 s44, s3, 10
    s_mov_b32 s11, 0x20000
    v_xor_b32 v4, s38, v3
    v_xor_b32 v5, s39, v3
    s_mov_b32 m0, s44
    v_xor_b32 v6, s39, v4
    s_mov_b32 s43, s40
    s_cmp_eq_u32 s7, 2
    s_waitcnt lgkmcnt(0)
    s_cselect_b64 s[8:9], s[68:69], s[66:67]
    s_cmp_eq_u32 s7, 3
    s_cselect_b64 s[8:9], s[64:65], s[8:9]
    buffer_load_dwordx4 v3, s[8:11], s40 offen nt lds
    s_add_u32 m0, s44, 8192
    s_add_u32 s40, s40, s41
    buffer_load_dwordx4 v4, s[8:11], s40 offen nt lds
    s_add_u32 m0, s44, 32768
    s_add_u32 s40, s40, s41
    buffer_load_dwordx4 v5, s[8:11], s40 offen nt lds
    s_add_u32 m0, s44, 40960
    s_add_u32 s40, s40, s41
    buffer_load_dwordx4 v6, s[8:11], s40 offen nt lds
    s_add_u32 m0, s44, 65536
    s_add_u32 s40, s40, s41
    s_load_dwordx2 s[12:13], s[0:1], 104
    s_load_dwordx2 s[28:29], s[0:1], 0
    s_load_dwordx2 s[30:31], s[0:1], 40
    s_load_dwordx2 s[16:17], s[0:1], 8
    s_load_dwordx2 s[20:21], s[0:1], 16
    s_load_dwordx2 s[24:25], s[0:1], 24
    s_getpc_b64 s[34:35]
L_pc:
    s_and_b32 s5, s5, 7
    v_and_b32 v0, 63, v0
    v_lshlrev_b32 v16, 4, v0
    s_mov_b32 s27, 0x20000
    s_mov_b32 s26, s10
    s_xor_b32 s36, s43, 512
    s_add_u32 s43, s43, 32768
    s_cmp_eq_u32 s7, 3
    s_cselect_b32 s43, s40, s43
    s_cmp_lt_u32 s7, 2
    s_cselect_b32 s43, s36, s43
    s_cselect_b32 s63, s42, s63
    s_waitcnt lgkmcnt(0)
    s_cselect_b64 s[24:25], s[24:25], s[8:9]
    s_lshl_b32 s33, s4, 3
    s_add_u32 s33, s33, s3
    s_lshl_b32 s33, s33, 7
    s_min_u32 s33, s33, L_end-L_pc-64
    s_add_u32 s36, s33, 64
    s_load_dword s100, s[34:35], s33
    s_load_dword s101, s[34:35], s36
    s_load_dword s32, s[12:13], 0
    s_mov_b32 s14, 0x1000000
    s_mov_b32 s15, 0x20000
    s_mov_b32 s19, 0x20000
    s_mov_b32 s52, 0x3e0293ee
    s_cmp_eq_u32 s7, 3
    s_cbranch_scc1 L_roleB
    s_mov_b32 s18, 0x8000000
    s_mov_b32 s22, 0x8000000
    s_mov_b32 s23, 0x20000
    s_lshl_b32 s45, s6, 5
    s_add_u32 s45, s45, s4
    s_lshl_b32 s45, s45, 21
    s_add_u32 s45, s45, 1572864
    s_lshl_b32 s57, s7, 3
    s_add_u32 s57, s57, s3
    s_lshl_b32 s48, s57, 11
    s_add_u32 s48, s48, s45
    s_cmp_eq_u32 s7, 2
    s_cbranch_scc1 L_rolePU
    s_lshl_b32 s33, s63, 8
    s_lshl_b32 s36, s3, 5
    s_add_u32 s49, s33, s36
    s_add_u32 s50, s49, 1024
    s_load_dwordx8 s[64:71], s[30:31], s49
    s_load_dwordx8 s[72:79], s[30:31], s50
    s_load_dwordx8 s[80:87], s[28:29], s49
    s_load_dwordx8 s[88:95], s[28:29], s50
    v_and_b32 v8, 1, v2
    v_lshlrev_b32 v7, 15, v8
    v_lshrrev_b32 v9, 1, v2
    v_lshl_add_u32 v7, v9, 10, v7
    v_lshrrev_b32 v9, 2, v1
    v_lshl_add_u32 v7, v9, 8, v7
    v_and_b32 v10, 3, v0
    v_lshl_add_u32 v7, v10, 3, v7
    v_lshl_or_b32 v9, v8, 2, v9
    v_xor_b32 v9, s3, v9
    v_lshl_add_u32 v200, v9, 5, v7
    v_add_u32 v201, 65536, v200
    v_lshrrev_b32 v7, 3, v0
    v_lshlrev_b32 v7, 8, v7
    v_and_b32 v8, 7, v0
    v_lshl_add_u32 v7, v8, 2, v7
    s_add_u32 s36, s36, 143360
    v_add_u32 v202, s36, v7
    v_and_b32 v7, 1, v0
    v_lshlrev_b32 v8, 8, v7
    v_lshl_add_u32 v8, v2, 4, v8
    v_add_u32 v203, 143360, v8
    v_lshlrev_b32 v8, 11, v7
    v_lshl_add_u32 v204, v2, 4, v8
    s_lshl_b32 s38, s4, 12
    s_lshl_b32 s36, s63, 9
    s_add_u32 s38, s38, s36
    s_lshl_b32 s36, s3, 6
    s_add_u32 s38, s38, s36
    s_xor_b32 s39, s38, 8192
    s_add_u32 s38, s38, 786432
    s_add_u32 s39, s39, 655360
    s_sub_u32 s33, 1, s2
    s_and_b32 s33, s33, 3
    s_and_b32 s36, s4, 28
    s_or_b32 s33, s33, s36
    s_add_u32 s36, s33, s2
    s_mul_i32 s36, s36, 3
    s_bfe_u32 s36, s36, 0x10002
    s_lshl_b32 s55, s36, 23
    s_lshl_b32 s36, s33, 18
    s_add_u32 s55, s55, s36
    s_add_u32 s55, s55, s44
    s_mul_i32 s36, s7, 49152
    s_sub_u32 s55, s55, s36
    s_add_u32 s55, s55, 253952
    v_lshrrev_b32 v9, 3, v0
    v_and_b32 v10, 7, v0
    v_and_b32 v11, 1, v2
    v_lshlrev_b32 v11, 1, v11
    v_xor_b32 v10, v10, v11
    v_lshlrev_b32 v10, 4, v10
    v_lshl_add_u32 v17, v9, 10, v10
    v_xor_b32 v18, 64, v17
    s_and_b32 s33, s3, 3
    s_lshl_b32 s46, s4, 17
    s_lshl_b32 s36, s33, 15
    s_add_u32 s46, s46, s36
    s_cmp_lt_u32 s3, 4
    s_cselect_b32 s36, 0, 0
    s_xor_b32 s36, s36, s5
    s_lshl_b32 s36, s36, 7
    s_add_u32 s46, s46, s36
    s_cmp_lt_u32 s3, 4
    s_mov_b32 s47, 114688
    s_cmov_b32 s47, 81920
    s_lshl_b32 s36, s33, 12
    s_add_u32 s47, s47, s36
    s_lshl_b32 s51, s4, 1
    s_add_u32 s51, s51, s6
    s_lshl_b32 s51, s51, 11
    s_add_u32 s51, s51, 655360
    v_and_b32 v36, 31, v0
    v_lshlrev_b32 v36, 3, v36
    v_lshrrev_b32 v7, 5, v0
    v_lshl_add_u32 v36, v7, 2, v36
    s_lshl_b32 s33, s3, 8
    s_add_u32 s33, s33, 141312
    v_add_u32 v36, s33, v36
    v_lshl_add_u32 v37, v1, 4, s33
    v_mov_b32 v60, 0xff7fffff
    v_mov_b32 v61, 0
    v_lshlrev_b32 v38, 5, v1
    v_lshl_add_u32 v38, v2, 3, v38
    s_lshl_b32 s33, s3, 9
    s_add_u32 s33, s33, 132096
    v_add_u32 v38, s33, v38
    s_lshl_b32 s33, s3, 2
    s_add_u32 s33, s33, 131584
    v_mov_b32 v39, s33
    v_mov_b32 v43, 131584
    v_lshrrev_b32 v44, 5, v0
    v_mul_u32_u24 v44, 1536, v44
    v_add_u32 v44, v44, v16
    v_add_u32 v44, 132096, v44
    s_lshl_b32 s61, s4, 3
    s_add_u32 s61, s61, s5
    s_lshl_b32 s61, s61, 9
    s_add_u32 s61, s61, 393216
    v_mov_b32 v52, 0
    v_mov_b32 v53, 0
    v_mov_b32 v54, 0
    v_mov_b32 v55, 0
    v_mov_b32 v56, 0
    v_mov_b32 v57, 0
    v_mov_b32 v58, 0
    v_mov_b32 v59, 0
    s_waitcnt vmcnt(3)
    buffer_load_dwordx4 v3, s[24:27], s43 offen nt lds
    s_add_u32 m0, s44, 73728
    s_add_u32 s43, s43, s41
    s_waitcnt vmcnt(3)
    buffer_load_dwordx4 v4, s[24:27], s43 offen nt lds
    s_add_u32 m0, s44, 98304
    s_add_u32 s43, s43, s41
    s_waitcnt lgkmcnt(0)
    s_add_u32 s32, s32, 1
    v_writelane_b32 v205, s64, 0
    v_writelane_b32 v205, s65, 1
    v_writelane_b32 v205, s66, 2
    v_writelane_b32 v205, s67, 3
    v_writelane_b32 v205, s68, 4
    v_writelane_b32 v205, s69, 5
    v_writelane_b32 v205, s70, 6
    v_writelane_b32 v205, s71, 7
    v_writelane_b32 v205, s72, 8
    v_writelane_b32 v205, s73, 9
    v_writelane_b32 v205, s74, 10
    v_writelane_b32 v205, s75, 11
    v_writelane_b32 v205, s76, 12
    v_writelane_b32 v205, s77, 13
    v_writelane_b32 v205, s78, 14
    v_writelane_b32 v205, s79, 15
    v_writelane_b32 v205, s80, 16
    v_writelane_b32 v205, s81, 17
    v_writelane_b32 v205, s82, 18
    v_writelane_b32 v205, s83, 19
    v_writelane_b32 v205, s84, 20
    v_writelane_b32 v205, s85, 21
    v_writelane_b32 v205, s86, 22
    v_writelane_b32 v205, s87, 23
    v_writelane_b32 v205, s88, 24
    v_writelane_b32 v205, s89, 25
    v_writelane_b32 v205, s90, 26
    v_writelane_b32 v205, s91, 27
    v_writelane_b32 v205, s92, 28
    v_writelane_b32 v205, s93, 29
    v_writelane_b32 v205, s94, 30
    v_writelane_b32 v205, s95, 31
    s_mov_b32 exec_lo, 0xffffffff
    s_mov_b32 exec_hi, 0x0
    ds_write_b32 v202, v205
    s_mov_b64 exec, -1
    v_mov_b32 v51, s32
    s_waitcnt vmcnt(3)
    buffer_load_dwordx4 v5, s[24:27], s43 offen nt lds
    s_add_u32 m0, s44, 106496
    s_add_u32 s43, s43, s41
    s_waitcnt vmcnt(3)
    s_waitcnt lgkmcnt(0)
    s_barrier
    ds_read_b128 v[160:163], v203 offset:0
    ds_read_b64_tr_b16 v[176:177], v200 offset:0
    ds_read_b64_tr_b16 v[178:179], v200 offset:8192
    ds_read_b128 v[164:167], v203 offset:64
    ds_read_b64_tr_b16 v[180:181], v200 offset:2048
    ds_read_b64_tr_b16 v[182:183], v200 offset:10240
    ds_read_b128 v[168:171], v203 offset:128
    ds_read_b64_tr_b16 v[184:185], v200 offset:4096
    ds_read_b64_tr_b16 v[186:187], v200 offset:12288
    ds_read_b128 v[172:175], v203 offset:192
    ds_read_b64_tr_b16 v[188:189], v200 offset:6144
    ds_read_b64_tr_b16 v[190:191], v200 offset:14336
    s_waitcnt lgkmcnt(9)
    v_mfma_f32_16x16x32_bf16 v[192:195], v[176:179], v[160:163], 0
    s_waitcnt lgkmcnt(6)
    v_mfma_f32_16x16x32_bf16 v[192:195], v[180:183], v[164:167], v[192:195]
    s_waitcnt lgkmcnt(3)
    v_mfma_f32_16x16x32_bf16 v[192:195], v[184:187], v[168:171], v[192:195]
    s_waitcnt lgkmcnt(0)
    v_mfma_f32_16x16x32_bf16 v[192:195], v[188:191], v[172:175], v[192:195]
    s_mov_b32 exec_lo, 0x30003
    s_mov_b32 exec_hi, 0x30003
    s_nop 5
    v_cvt_pk_bf16_f32 v48, v192, v193
    v_cvt_pk_bf16_f32 v49, v194, v195
    buffer_store_dwordx4 v[48:51], v204, s[12:15], s38 offen sc1
    s_mov_b64 exec, -1
    s_waitcnt vmcnt(4)
    buffer_load_dwordx4 v6, s[24:27], s43 offen nt lds
    s_add_u32 s43, s43, s41
    s_cmp_lt_u32 s3, 4
    s_cselect_b32 s33, 32, 80
    s_load_dwordx2 s[24:25], s[0:1], s33
    s_mov_b32 s26, 4194304
    s_load_dwordx2 s[8:9], s[0:1], 48
    s_mov_b32 s10, 0x1000000
    s_waitcnt lgkmcnt(0)
    s_waitcnt vmcnt(4)
    buffer_load_dwordx4 v[64:67], v16, s[8:11], s55 offen
    s_sub_u32 s55, s55, 8192
    s_waitcnt vmcnt(4)
    buffer_load_dwordx4 v[64:67], v16, s[8:11], s55 offen
    s_sub_u32 s55, s55, 8192
    s_waitcnt vmcnt(4)
    buffer_load_dwordx4 v[64:67], v16, s[8:11], s55 offen
    s_sub_u32 s55, s55, 8192
    s_waitcnt vmcnt(3)
    buffer_load_dwordx4 v[64:67], v16, s[8:11], s55 offen
    s_sub_u32 s55, s55, 8192
    s_waitcnt vmcnt(4)
    s_waitcnt lgkmcnt(0)
    s_barrier
    ds_read_b128 v[160:163], v203 offset:512
    ds_read_b64_tr_b16 v[176:177], v201 offset:0
    ds_read_b64_tr_b16 v[178:179], v201 offset:8192
    ds_read_b128 v[164:167], v203 offset:576
    ds_read_b64_tr_b16 v[180:181], v201 offset:2048
    ds_read_b64_tr_b16 v[182:183], v201 offset:10240
    ds_read_b128 v[168:171], v203 offset:640
    ds_read_b64_tr_b16 v[184:185], v201 offset:4096
    ds_read_b64_tr_b16 v[186:187], v201 offset:12288
    ds_read_b128 v[172:175], v203 offset:704
    ds_read_b64_tr_b16 v[188:189], v201 offset:6144
    ds_read_b64_tr_b16 v[190:191], v201 offset:14336
    s_waitcnt lgkmcnt(9)
    v_mfma_f32_16x16x32_bf16 v[192:195], v[176:179], v[160:163], 0
    s_waitcnt lgkmcnt(6)
    v_mfma_f32_16x16x32_bf16 v[192:195], v[180:183], v[164:167], v[192:195]
    s_waitcnt lgkmcnt(3)
    v_mfma_f32_16x16x32_bf16 v[192:195], v[184:187], v[168:171], v[192:195]
    s_waitcnt lgkmcnt(0)
    v_mfma_f32_16x16x32_bf16 v[192:195], v[188:191], v[172:175], v[192:195]
    s_mov_b32 exec_lo, 0x30003
    s_mov_b32 exec_hi, 0x30003
    s_nop 5
    v_cvt_pk_bf16_f32 v48, v192, v193
    v_cvt_pk_bf16_f32 v49, v194, v195
    buffer_store_dwordx4 v[48:51], v204, s[12:15], s39 offen sc1
    s_mov_b64 exec, -1
    s_waitcnt vmcnt(4)
    buffer_load_dwordx4 v[64:67], v16, s[8:11], s55 offen
    s_sub_u32 s55, s55, 8192
    s_waitcnt vmcnt(4)
    buffer_load_dwordx4 v[64:67], v16, s[8:11], s55 offen
    s_sub_u32 s55, s55, 8192
    s_add_u32 s54, s48, 0
    s_waitcnt vmcnt(4)
    buffer_load_dwordx4 v[72:75], v16, s[16:19], s54 offen offset:0 nt
    s_waitcnt vmcnt(4)
    buffer_load_dwordx4 v[76:79], v16, s[16:19], s54 offen offset:1024 nt
    s_add_u32 s54, s48, 49152
    s_waitcnt vmcnt(3)
    buffer_load_dwordx4 v[80:83], v16, s[16:19], s54 offen offset:0 nt
    s_waitcnt vmcnt(3)
    buffer_load_dwordx4 v[84:87], v16, s[16:19], s54 offen offset:1024 nt
    s_branch L_acommon
L_rolePU:
    v_lshrrev_b32 v7, 3, v1
    v_lshlrev_b32 v7, 15, v7
    v_bfe_u32 v8, v1, 2, 1
    v_lshl_add_u32 v7, v8, 13, v7
    v_and_b32 v8, 3, v1
    v_lshl_add_u32 v7, v8, 8, v7
    v_add_u32 v7, s44, v7
    v_xor_b32 v8, v2, v1
    v_lshl_add_u32 v216, v8, 4, v7
    v_xor_b32 v217, 64, v216
    v_xor_b32 v218, 128, v216
    v_xor_b32 v219, 192, v216
    v_add_u32 v220, 65536, v216
    v_add_u32 v221, 65536, v217
    v_add_u32 v222, 65536, v218
    v_add_u32 v223, 65536, v219
    v_and_b32 v13, 31, v0
    v_lshlrev_b32 v13, 3, v13
    v_lshrrev_b32 v7, 5, v0
    v_lshl_add_u32 v13, v7, 2, v13
    s_lshl_b32 s33, s3, 8
    s_add_u32 s33, s33, 151552
    v_add_u32 v13, s33, v13
    v_and_b32 v14, 1, v0
    v_lshlrev_b32 v14, 8, v14
    v_lshl_add_u32 v14, v2, 4, v14
    v_add_u32 v14, 151552, v14
    s_lshl_b32 s49, s63, 12
    s_lshl_b32 s36, s3, 11
    s_add_u32 s49, s49, s36
    s_add_u32 s49, s49, 786432
    v_lshlrev_b32 v15, 15, v1
    v_lshl_add_u32 v15, v2, 4, v15
    s_lshl_b32 s50, s63, 10
    s_lshl_b32 s36, s6, 9
    s_add_u32 s50, s50, s36
    s_lshl_b32 s36, s3, 6
    s_add_u32 s50, s50, s36
    s_add_u32 s50, s50, 196608
    s_lshr_b32 s53, s63, 2
    s_lshl_b32 s53, s53, 7
    s_and_b32 s36, s63, 3
    s_lshl_b32 s36, s36, 3
    s_add_u32 s53, s53, s36
    s_lshl_b32 s36, s6, 2
    s_add_u32 s53, s53, s36
    s_add_u32 s53, s53, 262144
    v_lshlrev_b32 v197, 10, v0
    s_sub_u32 s33, 1, s2
    s_and_b32 s33, s33, 3
    s_and_b32 s36, s4, 28
    s_or_b32 s33, s33, s36
    s_add_u32 s36, s33, s2
    s_mul_i32 s36, s36, 3
    s_bfe_u32 s36, s36, 0x10002
    s_lshl_b32 s55, s36, 23
    s_lshl_b32 s36, s33, 18
    s_add_u32 s55, s55, s36
    s_add_u32 s55, s55, s44
    s_mul_i32 s36, s7, 49152
    s_sub_u32 s55, s55, s36
    s_add_u32 s55, s55, 253952
    v_lshrrev_b32 v9, 3, v0
    v_and_b32 v10, 7, v0
    v_and_b32 v11, 1, v2
    v_lshlrev_b32 v11, 1, v11
    v_xor_b32 v10, v10, v11
    v_lshlrev_b32 v10, 4, v10
    v_lshl_add_u32 v17, v9, 10, v10
    v_xor_b32 v18, 64, v17
    s_and_b32 s33, s3, 3
    s_lshl_b32 s46, s4, 17
    s_lshl_b32 s36, s33, 15
    s_add_u32 s46, s46, s36
    s_cmp_lt_u32 s3, 4
    s_cselect_b32 s36, 0, 0
    s_xor_b32 s36, s36, s5
    s_lshl_b32 s36, s36, 7
    s_add_u32 s46, s46, s36
    s_cmp_lt_u32 s3, 4
    s_mov_b32 s47, 114688
    s_cmov_b32 s47, 81920
    s_lshl_b32 s36, s33, 12
    s_add_u32 s47, s47, s36
    s_lshl_b32 s51, s4, 1
    s_add_u32 s51, s51, s6
    s_lshl_b32 s51, s51, 11
    s_add_u32 s51, s51, 655360
    v_and_b32 v36, 31, v0
    v_lshlrev_b32 v36, 3, v36
    v_lshrrev_b32 v7, 5, v0
    v_lshl_add_u32 v36, v7, 2, v36
    s_lshl_b32 s33, s3, 8
    s_add_u32 s33, s33, 141312
    v_add_u32 v36, s33, v36
    v_lshl_add_u32 v37, v1, 4, s33
    v_mov_b32 v60, 0xff7fffff
    v_mov_b32 v61, 0
    v_lshlrev_b32 v38, 5, v1
    v_lshl_add_u32 v38, v2, 3, v38
    s_lshl_b32 s33, s3, 9
    s_add_u32 s33, s33, 132096
    v_add_u32 v38, s33, v38
    s_lshl_b32 s33, s3, 2
    s_add_u32 s33, s33, 131584
    v_mov_b32 v39, s33
    v_mov_b32 v43, 131584
    v_lshrrev_b32 v44, 5, v0
    v_mul_u32_u24 v44, 1536, v44
    v_add_u32 v44, v44, v16
    v_add_u32 v44, 132096, v44
    s_lshl_b32 s61, s4, 3
    s_add_u32 s61, s61, s5
    s_lshl_b32 s61, s61, 9
    s_add_u32 s61, s61, 393216
    v_mov_b32 v52, 0
    v_mov_b32 v53, 0
    v_mov_b32 v54, 0
    v_mov_b32 v55, 0
    v_mov_b32 v56, 0
    v_mov_b32 v57, 0
    v_mov_b32 v58, 0
    v_mov_b32 v59, 0
    s_waitcnt vmcnt(3)
    buffer_load_dwordx4 v3, s[24:27], s43 offen nt lds
    s_add_u32 m0, s44, 73728
    s_add_u32 s43, s43, s41
    s_waitcnt vmcnt(3)
    buffer_load_dwordx4 v4, s[24:27], s43 offen nt lds
    s_add_u32 m0, s44, 98304
    s_add_u32 s43, s43, s41
    s_waitcnt lgkmcnt(0)
    s_add_u32 s32, s32, 1
    v_mov_b32 v196, s32
    s_waitcnt vmcnt(3)
    buffer_load_dwordx4 v5, s[24:27], s43 offen nt lds
    s_add_u32 m0, s44, 106496
    s_add_u32 s43, s43, s41
    s_waitcnt vmcnt(3)
    buffer_load_dwordx4 v6, s[24:27], s43 offen nt lds
    s_add_u32 s43, s43, s41
    s_cmp_lt_u32 s3, 4
    s_cselect_b32 s33, 32, 80
    s_load_dwordx2 s[24:25], s[0:1], s33
    s_mov_b32 s26, 4194304
    s_load_dwordx2 s[8:9], s[0:1], 48
    s_mov_b32 s10, 0x1000000
    s_waitcnt lgkmcnt(0)
    s_waitcnt vmcnt(3)
    buffer_load_dwordx4 v[64:67], v16, s[8:11], s55 offen
    s_sub_u32 s55, s55, 8192
    s_waitcnt vmcnt(3)
    buffer_load_dwordx4 v[64:67], v16, s[8:11], s55 offen
    s_sub_u32 s55, s55, 8192
    s_waitcnt vmcnt(3)
    buffer_load_dwordx4 v[64:67], v16, s[8:11], s55 offen
    s_sub_u32 s55, s55, 8192
    s_waitcnt vmcnt(3)
    buffer_load_dwordx4 v[64:67], v16, s[8:11], s55 offen
    s_sub_u32 s55, s55, 8192
    s_add_u32 s54, s48, 0
    s_waitcnt vmcnt(3)
    buffer_load_dwordx4 v[72:75], v16, s[16:19], s54 offen offset:0 nt
    s_lshl_b32 s33, s63, 12
    s_lshl_b32 s36, s3, 9
    s_add_u32 s33, s33, s36
    s_add_u32 s33, s33, 786432
    s_add_u32 s34, s12, s33
    s_addc_u32 s35, s13, 0
    s_mov_b32 s38, s32
    s_mov_b32 s39, s32
    s_mov_b32 s37, 262144
L_h1h:
    s_load_dword s64, s[34:35], 12 glc
    s_load_dword s65, s[34:35], 76 glc
    s_load_dword s66, s[34:35], 140 glc
    s_load_dword s67, s[34:35], 204 glc
    s_load_dword s68, s[34:35], 268 glc
    s_load_dword s69, s[34:35], 332 glc
    s_load_dword s70, s[34:35], 396 glc
    s_load_dword s71, s[34:35], 460 glc
    s_sub_u32 s37, s37, 1
    s_waitcnt lgkmcnt(0)
    s_cbranch_scc1 L_h1k
    s_xor_b64 s[64:65], s[64:65], s[38:39]
    s_xor_b64 s[66:67], s[66:67], s[38:39]
    s_xor_b64 s[68:69], s[68:69], s[38:39]
    s_xor_b64 s[70:71], s[70:71], s[38:39]
    s_or_b64 s[64:65], s[64:65], s[66:67]
    s_or_b64 s[68:69], s[68:69], s[70:71]
    s_or_b64 s[64:65], s[64:65], s[68:69]
    s_cbranch_scc1 L_h1h
L_h1k:
    s_barrier
    s_cmp_gt_u32 s3, 1
    s_cbranch_scc1 L_h1a
    buffer_load_dwordx4 v[176:179], v16, s[12:15], s49 offen sc1
    buffer_load_dwordx4 v[180:183], v16, s[12:15], s49 offen offset:1024 sc1
L_h1a:
    s_cmp_gt_u32 s3, 1
    s_cbranch_scc1 L_h1s
    s_mov_b32 s37, 262144
    s_waitcnt vmcnt(0)
L_h1c:
    v_bitop3_b32 v8, v179, v183, s32 bitop3:0x7e
    v_cmp_ne_u32 vcc, 0, v8
    s_cbranch_vccz L_h1d
    s_sub_u32 s37, s37, 1
    s_cbranch_scc1 L_h1d
    buffer_load_dwordx4 v[176:179], v16, s[12:15], s49 offen sc1
    buffer_load_dwordx4 v[180:183], v16, s[12:15], s49 offen offset:1024 sc1
    s_waitcnt vmcnt(0)
    s_branch L_h1c
L_h1d:
    v_lshlrev_b32 v8, 16, v176
    v_and_b32 v9, 0xffff0000, v176
    v_lshlrev_b32 v10, 16, v177
    v_and_b32 v11, 0xffff0000, v177
    v_lshlrev_b32 v176, 16, v180
    v_and_b32 v177, 0xffff0000, v180
    v_lshlrev_b32 v178, 16, v181
    v_and_b32 v179, 0xffff0000, v181
    v_pk_add_f32 v[8:9], v[8:9], v[176:177]
    v_pk_add_f32 v[10:11], v[10:11], v[178:179]
    s_nop 1
    v_permlane32_swap_b32 v8, v10
    v_permlane32_swap_b32 v9, v11
    v_pk_add_f32 v[8:9], v[8:9], v[10:11]
    v_cvt_pk_bf16_f32 v176, v8, v9
    ds_write_b32 v13, v176
L_h1s:
    s_waitcnt vmcnt(5)
    ds_read_b128 v[224:227], v216
    ds_read_b128 v[228:231], v217
    ds_read_b128 v[232:235], v218
    ds_read_b128 v[236:239], v219
    ds_read_b128 v[240:243], v220
    ds_read_b128 v[244:247], v221
    ds_read_b128 v[248:251], v222
    ds_read_b128 v[252:255], v223
    s_waitcnt lgkmcnt(0)
    s_barrier
    ds_read_b128 v[176:179], v14 offset:0
    ds_read_b128 v[180:183], v14 offset:64
    ds_read_b128 v[184:187], v14 offset:128
    ds_read_b128 v[188:191], v14 offset:192
    s_waitcnt lgkmcnt(3)
    v_mfma_f32_16x16x32_bf16 v[208:211], v[224:227], v[176:179], 0
    v_mfma_f32_16x16x32_bf16 v[212:215], v[240:243], v[176:179], 0
    s_waitcnt lgkmcnt(2)
    v_mfma_f32_16x16x32_bf16 v[208:211], v[228:231], v[180:183], v[208:211]
    v_mfma_f32_16x16x32_bf16 v[212:215], v[244:247], v[180:183], v[212:215]
    s_waitcnt lgkmcnt(1)
    v_mfma_f32_16x16x32_bf16 v[208:211], v[232:235], v[184:187], v[208:211]
    v_mfma_f32_16x16x32_bf16 v[212:215], v[248:251], v[184:187], v[212:215]
    s_waitcnt lgkmcnt(0)
    v_mfma_f32_16x16x32_bf16 v[208:211], v[236:239], v[188:191], v[208:211]
    v_mfma_f32_16x16x32_bf16 v[212:215], v[252:255], v[188:191], v[212:215]
    s_nop 6
    v_cvt_pk_bf16_f32 v168, v208, v209
    v_cvt_pk_bf16_f32 v169, v210, v211
    v_cvt_pk_bf16_f32 v170, v212, v213
    v_cvt_pk_bf16_f32 v171, v214, v215
    s_mov_b32 exec_lo, 0x30003
    s_mov_b32 exec_hi, 0x30003
    buffer_store_dwordx4 v[168:171], v15, s[12:15], s50 offen sc1
    s_mov_b64 exec, -1
    s_waitcnt vmcnt(0)
    s_barrier
    s_cmp_lg_u32 s3, 0
    s_cbranch_scc1 L_p2s_1
    s_mov_b64 exec, 0xffff
    buffer_store_dword v196, v197, s[12:15], s53 offen sc1
    s_mov_b64 exec, -1
L_p2s_1:
    s_waitcnt vmcnt(5)
    buffer_load_dwordx4 v[76:79], v16, s[16:19], s54 offen offset:1024 nt
    s_add_u32 s54, s48, 49152
    s_waitcnt vmcnt(5)
    buffer_load_dwordx4 v[80:83], v16, s[16:19], s54 offen offset:0 nt
    s_waitcnt vmcnt(5)
    buffer_load_dwordx4 v[84:87], v16, s[16:19], s54 offen offset:1024 nt
    s_add_u32 s54, s48, 98304
    s_waitcnt vmcnt(3)
    buffer_load_dwordx4 v[88:91], v16, s[16:19], s54 offen offset:0 nt
    s_waitcnt vmcnt(3)
    buffer_load_dwordx4 v[92:95], v16, s[16:19], s54 offen offset:1024 nt
    s_add_u32 s54, s48, 147456
    s_waitcnt vmcnt(3)
    buffer_load_dwordx4 v[96:99], v16, s[16:19], s54 offen offset:0 nt
    s_waitcnt vmcnt(3)
    buffer_load_dwordx4 v[100:103], v16, s[16:19], s54 offen offset:1024 nt
    s_load_dwordx2 s[28:29], s[0:1], 88
    v_lshrrev_b32 v9, 2, v1
    v_lshlrev_b32 v7, 10, v2
    v_lshl_add_u32 v7, v9, 7, v7
    v_and_b32 v10, 3, v0
    v_lshl_add_u32 v7, v10, 3, v7
    v_lshrrev_b32 v9, 1, v9
    v_and_b32 v8, 1, v2
    v_lshl_or_b32 v9, v8, 1, v9
    s_and_b32 s33, s3, 3
    v_xor_b32 v9, s33, v9
    v_lshl_add_u32 v7, v9, 5, v7
    s_cmp_lt_u32 s3, 4
    s_mov_b32 s36, 114688
    s_cmov_b32 s36, 81920
    s_mov_b32 s40, 524288
    s_cmov_b32 s40, 393216
    v_add_u32 v244, s36, v7
    s_lshl_b32 s36, s4, 12
    s_add_u32 s40, s40, s36
    s_lshl_b32 s36, s33, 9
    s_add_u32 s40, s40, s36
    v_lshrrev_b32 v9, 5, v0
    v_mul_u32_u24 v245, 1536, v9
    v_add_u32 v245, v245, v16
    s_and_b32 s36, s3, 4
    s_lshl_b32 s36, s36, 1
    s_add_u32 s33, s36, s33
    v_lshl_add_u32 v9, v9, 2, s33
    v_and_b32 v8, 31, v0
    v_mul_u32_u24 v246, 272, v9
    v_lshl_add_u32 v246, v8, 3, v246
    v_add_u32 v246, 151552, v246
    v_mul_u32_u24 v247, 136, v9
    v_lshl_add_u32 v247, v8, 2, v247
    v_add_u32 v247, 156160, v247
    v_and_b32 v9, 7, v0
    v_add_u32 v9, s36, v9
    v_mul_u32_u24 v248, 272, v9
    v_lshl_add_u32 v248, v2, 4, v248
    v_add_u32 v248, 151552, v248
    v_mul_u32_u24 v249, 136, v9
    v_add_u32 v249, 156160, v249
    v_mov_b32 v240, 0
    v_mov_b32 v241, 0
    v_and_b32 v8, 1, v0
    v_add_u32 v8, -1, v8
    v_and_b32 v242, 0xff7fffff, v8
    s_mov_b32 s30, 4096
    s_mov_b32 s31, 0x20000
    v_lshlrev_b32 v250, 12, v2
    v_lshl_add_u32 v250, v1, 2, v250
    s_cmp_lt_u32 s3, 4
    s_cselect_b32 s41, 0, 0
    s_xor_b32 s41, s41, s5
    s_lshl_b32 s41, s41, 3
    s_add_u32 s41, s41, s3
    s_lshr_b32 s41, s41, 1
    s_lshl_b32 s41, s41, 13
    s_and_b32 s36, s3, 1
    s_lshl_b32 s36, s36, 6
    s_add_u32 s41, s41, s36
    v_mov_b32 v251, 0xff
    s_lshl_b32 s36, s4, 7
    s_add_u32 s41, s41, s36
    s_add_u32 s41, s41, 4194304
    v_mov_b32 v253, s32
    s_xor_b32 s38, s5, 0
    s_lshl_b32 s42, s38, 2
    s_lshr_b32 s36, s4, 3
    s_add_u32 s42, s42, s36
    s_lshl_b32 s42, s42, 1
    s_bfe_u32 s36, s4, 0x10001
    s_add_u32 s42, s42, s36
    s_lshl_b32 s42, s42, 12
    s_and_b32 s33, s4, 1
    s_lshl_b32 s43, s33, 6
    s_add_u32 s42, s42, s43
    s_add_u32 s42, s42, 4194304
    s_lshl_b32 s43, s33, 4
    s_and_b32 s36, s36, 1
    s_lshl_b32 s36, s36, 11
    s_add_u32 s43, s43, s36
    s_lshr_b32 s36, s4, 4
    s_lshl_b32 s36, s36, 10
    s_add_u32 s43, s43, s36
    s_lshl_b32 s36, s38, 7
    s_add_u32 s43, s43, s36
    s_bfe_u32 s36, s4, 0x20002
    s_lshl_b32 s36, s36, 5
    s_add_u32 s43, s43, s36
    v_lshlrev_b32 v254, 3, v0
    v_mov_b32 v8, s5
    v_mov_b32 v9, v0
    s_sub_u32 s59, s6, 1
    s_not_b32 s58, s59
    s_cmp_eq_u32 s3, s7
    s_cselect_b64 s[58:59], s[58:59], -1
    v_mul_u32_u24 v238, 272, v8
    v_lshl_add_u32 v238, v9, 3, v238
    v_add_u32 v238, 151552, v238
    v_mul_u32_u24 v239, 136, v8
    v_lshl_add_u32 v239, v9, 2, v239
    v_add_u32 v239, 156160, v239
    s_add_u32 s54, s48, 196608
    s_waitcnt vmcnt(3)
    buffer_load_dwordx4 v[104:107], v16, s[16:19], s54 offen offset:0 nt
    s_waitcnt vmcnt(3)
    buffer_load_dwordx4 v[108:111], v16, s[16:19], s54 offen offset:1024 nt
    s_add_u32 s54, s48, 245760
    s_waitcnt vmcnt(3)
    buffer_load_dwordx4 v[112:115], v16, s[16:19], s54 offen offset:0 nt
    s_waitcnt vmcnt(3)
    buffer_load_dwordx4 v[116:119], v16, s[16:19], s54 offen offset:1024 nt
    buffer_load_dwordx4 v[20:23], v16, s[12:15], s51 offen
    buffer_load_dwordx4 v[24:27], v16, s[12:15], s51 offen offset:1024
    s_add_u32 s54, s48, 294912
    s_waitcnt vmcnt(5)
    buffer_load_dwordx4 v[120:123], v16, s[16:19], s54 offen offset:0 nt
    s_waitcnt vmcnt(5)
    buffer_load_dwordx4 v[124:127], v16, s[16:19], s54 offen offset:1024 nt
    s_add_u32 s54, s48, 344064
    s_waitcnt vmcnt(5)
    buffer_load_dwordx4 v[128:131], v16, s[16:19], s54 offen offset:0 nt
    s_waitcnt vmcnt(5)
    buffer_load_dwordx4 v[132:135], v16, s[16:19], s54 offen offset:1024 nt
    s_mov_b32 s37, 262144
    s_waitcnt vmcnt(4)
L_qlp_2:
    v_bitop3_b32 v8, v23, v27, s32 bitop3:0x7e
    v_cmp_ne_u32 vcc, 0, v8
    s_cbranch_vccz L_qok_3
    s_sub_u32 s37, s37, 1
    s_cbranch_scc1 L_qok_3
    buffer_load_dwordx4 v[20:23], v16, s[12:15], s51 offen sc1
    buffer_load_dwordx4 v[24:27], v16, s[12:15], s51 offen offset:1024 sc1
    s_waitcnt vmcnt(0)
    s_branch L_qlp_2
L_qok_3:
    v_lshlrev_b32 v8, 16, v20
    v_and_b32 v9, 0xffff0000, v20
    v_lshlrev_b32 v10, 16, v21
    v_and_b32 v11, 0xffff0000, v21
    v_lshlrev_b32 v20, 16, v24
    v_and_b32 v21, 0xffff0000, v24
    v_lshlrev_b32 v22, 16, v25
    v_and_b32 v23, 0xffff0000, v25
    v_pk_add_f32 v[8:9], v[8:9], v[20:21]
    v_pk_add_f32 v[10:11], v[10:11], v[22:23]
    s_nop 1
    v_permlane32_swap_b32 v8, v10
    v_permlane32_swap_b32 v9, v11
    v_pk_add_f32 v[8:9], v[8:9], v[10:11]
    v_cvt_pk_bf16_f32 v20, v8, v9
    ds_write_b32 v36, v20
    ds_read_b128 v[24:27], v37
    s_waitcnt lgkmcnt(0)
    v_mov_b32 v28, 0
    v_mov_b32 v29, 0
    v_dot2c_f32_bf16 v28, v72, v24
    v_dot2c_f32_bf16 v29, v76, v24
    v_dot2c_f32_bf16 v28, v73, v25
    v_dot2c_f32_bf16 v29, v77, v25
    v_dot2c_f32_bf16 v28, v74, v26
    v_dot2c_f32_bf16 v29, v78, v26
    v_dot2c_f32_bf16 v28, v75, v27
    v_dot2c_f32_bf16 v29, v79, v27
    s_nop 1
    v_add_f32_dpp v160, v28, v28 row_ror:8 row_mask:0xf bank_mask:0x3
    v_add_f32_dpp v160, v29, v29 row_ror:8 row_mask:0xf bank_mask:0xc
    s_nop 1
    v_add_f32_dpp v160, v160, v160 row_half_mirror row_mask:0xf bank_mask:0xf
    s_nop 1
    v_add_f32_dpp v160, v160, v160 quad_perm:[1,0,3,2] row_mask:0xf bank_mask:0xf
    s_nop 1
    v_add_f32_dpp v160, v160, v160 quad_perm:[2,3,0,1] row_mask:0xf bank_mask:0xf
    v_mov_b32 v28, 0
    v_mov_b32 v29, 0
    v_dot2c_f32_bf16 v28, v80, v24
    v_dot2c_f32_bf16 v29, v84, v24
    v_dot2c_f32_bf16 v28, v81, v25
    v_dot2c_f32_bf16 v29, v85, v25
    v_dot2c_f32_bf16 v28, v82, v26
    v_dot2c_f32_bf16 v29, v86, v26
    v_dot2c_f32_bf16 v28, v83, v27
    v_dot2c_f32_bf16 v29, v87, v27
    s_nop 1
    v_add_f32_dpp v161, v28, v28 row_ror:8 row_mask:0xf bank_mask:0x3
    v_add_f32_dpp v161, v29, v29 row_ror:8 row_mask:0xf bank_mask:0xc
    s_nop 1
    v_add_f32_dpp v161, v161, v161 row_half_mirror row_mask:0xf bank_mask:0xf
    s_nop 1
    v_add_f32_dpp v161, v161, v161 quad_perm:[1,0,3,2] row_mask:0xf bank_mask:0xf
    s_nop 1
    v_add_f32_dpp v161, v161, v161 quad_perm:[2,3,0,1] row_mask:0xf bank_mask:0xf
    s_add_u32 s54, s48, 393216
    s_waitcnt vmcnt(3)
    buffer_load_dwordx4 v[136:139], v16, s[16:19], s54 offen offset:0 nt
    s_waitcnt vmcnt(3)
    buffer_load_dwordx4 v[140:143], v16, s[16:19], s54 offen offset:1024 nt
    s_add_u32 s54, s48, 442368
    s_waitcnt vmcnt(3)
    buffer_load_dwordx4 v[144:147], v16, s[16:19], s54 offen offset:0 nt
    s_waitcnt vmcnt(3)
    buffer_load_dwordx4 v[148:151], v16, s[16:19], s54 offen offset:1024 nt
    v_mov_b32 v28, 0
    v_mov_b32 v29, 0
    v_dot2c_f32_bf16 v28, v88, v24
    v_dot2c_f32_bf16 v29, v92, v24
    v_dot2c_f32_bf16 v28, v89, v25
    v_dot2c_f32_bf16 v29, v93, v25
    v_dot2c_f32_bf16 v28, v90, v26
    v_dot2c_f32_bf16 v29, v94, v26
    v_dot2c_f32_bf16 v28, v91, v27
    v_dot2c_f32_bf16 v29, v95, v27
    s_nop 1
    v_add_f32_dpp v162, v28, v28 row_ror:8 row_mask:0xf bank_mask:0x3
    v_add_f32_dpp v162, v29, v29 row_ror:8 row_mask:0xf bank_mask:0xc
    s_nop 1
    v_add_f32_dpp v162, v162, v162 row_half_mirror row_mask:0xf bank_mask:0xf
    s_nop 1
    v_add_f32_dpp v162, v162, v162 quad_perm:[1,0,3,2] row_mask:0xf bank_mask:0xf
    s_nop 1
    v_add_f32_dpp v162, v162, v162 quad_perm:[2,3,0,1] row_mask:0xf bank_mask:0xf
    v_mov_b32 v28, 0
    v_mov_b32 v29, 0
    v_dot2c_f32_bf16 v28, v96, v24
    v_dot2c_f32_bf16 v29, v100, v24
    v_dot2c_f32_bf16 v28, v97, v25
    v_dot2c_f32_bf16 v29, v101, v25
    v_dot2c_f32_bf16 v28, v98, v26
    v_dot2c_f32_bf16 v29, v102, v26
    v_dot2c_f32_bf16 v28, v99, v27
    v_dot2c_f32_bf16 v29, v103, v27
    s_nop 1
    v_add_f32_dpp v163, v28, v28 row_ror:8 row_mask:0xf bank_mask:0x3
    v_add_f32_dpp v163, v29, v29 row_ror:8 row_mask:0xf bank_mask:0xc
    s_nop 1
    v_add_f32_dpp v163, v163, v163 row_half_mirror row_mask:0xf bank_mask:0xf
    s_nop 1
    v_add_f32_dpp v163, v163, v163 quad_perm:[1,0,3,2] row_mask:0xf bank_mask:0xf
    s_nop 1
    v_add_f32_dpp v163, v163, v163 quad_perm:[2,3,0,1] row_mask:0xf bank_mask:0xf
    v_mov_b32 v28, 0
    v_mov_b32 v29, 0
    v_dot2c_f32_bf16 v28, v104, v24
    v_dot2c_f32_bf16 v29, v108, v24
    v_dot2c_f32_bf16 v28, v105, v25
    v_dot2c_f32_bf16 v29, v109, v25
    v_dot2c_f32_bf16 v28, v106, v26
    v_dot2c_f32_bf16 v29, v110, v26
    v_dot2c_f32_bf16 v28, v107, v27
    v_dot2c_f32_bf16 v29, v111, v27
    s_nop 1
    v_add_f32_dpp v164, v28, v28 row_ror:8 row_mask:0xf bank_mask:0x3
    v_add_f32_dpp v164, v29, v29 row_ror:8 row_mask:0xf bank_mask:0xc
    s_nop 1
    v_add_f32_dpp v164, v164, v164 row_half_mirror row_mask:0xf bank_mask:0xf
    s_nop 1
    v_add_f32_dpp v164, v164, v164 quad_perm:[1,0,3,2] row_mask:0xf bank_mask:0xf
    s_nop 1
    v_add_f32_dpp v164, v164, v164 quad_perm:[2,3,0,1] row_mask:0xf bank_mask:0xf
    s_add_u32 s54, s48, 0
    s_waitcnt vmcnt(3)
    buffer_load_dwordx4 v[152:155], v16, s[20:23], s54 offen offset:0 nt
    s_waitcnt vmcnt(3)
    buffer_load_dwordx4 v[156:159], v16, s[20:23], s54 offen offset:1024 nt
    s_add_u32 s54, s48, 49152
    s_waitcnt vmcnt(3)
    buffer_load_dwordx4 v[64:67], v16, s[20:23], s54 offen offset:0 nt
    s_waitcnt vmcnt(3)
    buffer_load_dwordx4 v[68:71], v16, s[20:23], s54 offen offset:1024 nt
    v_mov_b32 v28, 0
    v_mov_b32 v29, 0
    v_dot2c_f32_bf16 v28, v112, v24
    v_dot2c_f32_bf16 v29, v116, v24
    v_dot2c_f32_bf16 v28, v113, v25
    v_dot2c_f32_bf16 v29, v117, v25
    v_dot2c_f32_bf16 v28, v114, v26
    v_dot2c_f32_bf16 v29, v118, v26
    v_dot2c_f32_bf16 v28, v115, v27
    v_dot2c_f32_bf16 v29, v119, v27
    s_nop 1
    v_add_f32_dpp v165, v28, v28 row_ror:8 row_mask:0xf bank_mask:0x3
    v_add_f32_dpp v165, v29, v29 row_ror:8 row_mask:0xf bank_mask:0xc
    s_nop 1
    v_add_f32_dpp v165, v165, v165 row_half_mirror row_mask:0xf bank_mask:0xf
    s_nop 1
    v_add_f32_dpp v165, v165, v165 quad_perm:[1,0,3,2] row_mask:0xf bank_mask:0xf
    s_nop 1
    v_add_f32_dpp v165, v165, v165 quad_perm:[2,3,0,1] row_mask:0xf bank_mask:0xf
    v_mov_b32 v28, 0
    v_mov_b32 v29, 0
    v_dot2c_f32_bf16 v28, v120, v24
    v_dot2c_f32_bf16 v29, v124, v24
    v_dot2c_f32_bf16 v28, v121, v25
    v_dot2c_f32_bf16 v29, v125, v25
    v_dot2c_f32_bf16 v28, v122, v26
    v_dot2c_f32_bf16 v29, v126, v26
    v_dot2c_f32_bf16 v28, v123, v27
    v_dot2c_f32_bf16 v29, v127, v27
    s_nop 1
    v_add_f32_dpp v166, v28, v28 row_ror:8 row_mask:0xf bank_mask:0x3
    v_add_f32_dpp v166, v29, v29 row_ror:8 row_mask:0xf bank_mask:0xc
    s_nop 1
    v_add_f32_dpp v166, v166, v166 row_half_mirror row_mask:0xf bank_mask:0xf
    s_nop 1
    v_add_f32_dpp v166, v166, v166 quad_perm:[1,0,3,2] row_mask:0xf bank_mask:0xf
    s_nop 1
    v_add_f32_dpp v166, v166, v166 quad_perm:[2,3,0,1] row_mask:0xf bank_mask:0xf
    v_mov_b32 v28, 0
    v_mov_b32 v29, 0
    v_dot2c_f32_bf16 v28, v128, v24
    v_dot2c_f32_bf16 v29, v132, v24
    v_dot2c_f32_bf16 v28, v129, v25
    v_dot2c_f32_bf16 v29, v133, v25
    v_dot2c_f32_bf16 v28, v130, v26
    v_dot2c_f32_bf16 v29, v134, v26
    v_dot2c_f32_bf16 v28, v131, v27
    v_dot2c_f32_bf16 v29, v135, v27
    s_nop 1
    v_add_f32_dpp v167, v28, v28 row_ror:8 row_mask:0xf bank_mask:0x3
    v_add_f32_dpp v167, v29, v29 row_ror:8 row_mask:0xf bank_mask:0xc
    s_nop 1
    v_add_f32_dpp v167, v167, v167 row_half_mirror row_mask:0xf bank_mask:0xf
    s_nop 1
    v_add_f32_dpp v167, v167, v167 quad_perm:[1,0,3,2] row_mask:0xf bank_mask:0xf
    s_nop 1
    v_add_f32_dpp v167, v167, v167 quad_perm:[2,3,0,1] row_mask:0xf bank_mask:0xf
    s_add_u32 s54, s48, 98304
    s_waitcnt vmcnt(3)
    buffer_load_dwordx4 v[72:75], v16, s[20:23], s54 offen offset:0 nt
    s_waitcnt vmcnt(3)
    buffer_load_dwordx4 v[76:79], v16, s[20:23], s54 offen offset:1024 nt
    s_add_u32 s54, s48, 147456
    s_waitcnt vmcnt(3)
    buffer_load_dwordx4 v[80:83], v16, s[20:23], s54 offen offset:0 nt
    s_waitcnt vmcnt(3)
    buffer_load_dwordx4 v[84:87], v16, s[20:23], s54 offen offset:1024 nt
    v_mov_b32 v28, 0
    v_mov_b32 v29, 0
    v_dot2c_f32_bf16 v28, v136, v24
    v_dot2c_f32_bf16 v29, v140, v24
    v_dot2c_f32_bf16 v28, v137, v25
    v_dot2c_f32_bf16 v29, v141, v25
    v_dot2c_f32_bf16 v28, v138, v26
    v_dot2c_f32_bf16 v29, v142, v26
    v_dot2c_f32_bf16 v28, v139, v27
    v_dot2c_f32_bf16 v29, v143, v27
    s_nop 1
    v_add_f32_dpp v168, v28, v28 row_ror:8 row_mask:0xf bank_mask:0x3
    v_add_f32_dpp v168, v29, v29 row_ror:8 row_mask:0xf bank_mask:0xc
    s_nop 1
    v_add_f32_dpp v168, v168, v168 row_half_mirror row_mask:0xf bank_mask:0xf
    s_nop 1
    v_add_f32_dpp v168, v168, v168 quad_perm:[1,0,3,2] row_mask:0xf bank_mask:0xf
    s_nop 1
    v_add_f32_dpp v168, v168, v168 quad_perm:[2,3,0,1] row_mask:0xf bank_mask:0xf
    v_mov_b32 v28, 0
    v_mov_b32 v29, 0
    v_dot2c_f32_bf16 v28, v144, v24
    v_dot2c_f32_bf16 v29, v148, v24
    v_dot2c_f32_bf16 v28, v145, v25
    v_dot2c_f32_bf16 v29, v149, v25
    v_dot2c_f32_bf16 v28, v146, v26
    v_dot2c_f32_bf16 v29, v150, v26
    v_dot2c_f32_bf16 v28, v147, v27
    v_dot2c_f32_bf16 v29, v151, v27
    s_nop 1
    v_add_f32_dpp v169, v28, v28 row_ror:8 row_mask:0xf bank_mask:0x3
    v_add_f32_dpp v169, v29, v29 row_ror:8 row_mask:0xf bank_mask:0xc
    s_nop 1
    v_add_f32_dpp v169, v169, v169 row_half_mirror row_mask:0xf bank_mask:0xf
    s_nop 1
    v_add_f32_dpp v169, v169, v169 quad_perm:[1,0,3,2] row_mask:0xf bank_mask:0xf
    s_nop 1
    v_add_f32_dpp v169, v169, v169 quad_perm:[2,3,0,1] row_mask:0xf bank_mask:0xf
    v_max_f32 v31, v160, v169
    v_max3_f32 v31, v31, v161, v162
    v_max3_f32 v31, v31, v163, v164
    v_max3_f32 v31, v31, v165, v166
    v_max3_f32 v31, v31, v167, v168
    s_nop 1
    v_max_f32_dpp v31, v31, v31 row_ror:8 row_mask:0xf bank_mask:0xf
    v_mov_b32 v32, v31
    s_nop 1
    v_permlane16_swap_b32 v32, v31
    v_max_f32 v31, v31, v32
    v_mov_b32 v32, v31
    s_nop 1
    v_permlane32_swap_b32 v32, v31
    v_max_f32 v31, v31, v32
    v_mul_f32 v31, s52, v31
    ds_write_b32 v39, v31
    s_add_u32 s54, s48, 196608
    s_waitcnt vmcnt(3)
    buffer_load_dwordx4 v[88:91], v16, s[20:23], s54 offen offset:0 nt
    s_waitcnt vmcnt(3)
    buffer_load_dwordx4 v[92:95], v16, s[20:23], s54 offen offset:1024 nt
    s_add_u32 s54, s48, 245760
    s_waitcnt vmcnt(3)
    buffer_load_dwordx4 v[96:99], v16, s[20:23], s54 offen offset:0 nt
    s_waitcnt vmcnt(3)
    buffer_load_dwordx4 v[100:103], v16, s[20:23], s54 offen offset:1024 nt
    v_fma_f32 v160, v160, s52, -v31
    v_fma_f32 v161, v161, s52, -v31
    v_fma_f32 v162, v162, s52, -v31
    v_fma_f32 v163, v163, s52, -v31
    v_fma_f32 v164, v164, s52, -v31
    v_fma_f32 v165, v165, s52, -v31
    v_fma_f32 v166, v166, s52, -v31
    v_fma_f32 v167, v167, s52, -v31
    v_exp_f32 v160, v160
    v_exp_f32 v161, v161
    v_exp_f32 v162, v162
    v_exp_f32 v163, v163
    v_exp_f32 v164, v164
    v_exp_f32 v165, v165
    v_exp_f32 v166, v166
    v_exp_f32 v167, v167
    v_cvt_pk_bf16_f32 v176, v160, 0
    v_cvt_pk_bf16_f32 v177, 0, v160
    v_add_f32 v61, v61, v160
    v_cvt_pk_bf16_f32 v178, v161, 0
    v_cvt_pk_bf16_f32 v179, 0, v161
    v_add_f32 v61, v61, v161
    v_cvt_pk_bf16_f32 v180, v162, 0
    v_cvt_pk_bf16_f32 v181, 0, v162
    v_add_f32 v61, v61, v162
    v_cvt_pk_bf16_f32 v182, v163, 0
    v_cvt_pk_bf16_f32 v183, 0, v163
    v_add_f32 v61, v61, v163
    v_cvt_pk_bf16_f32 v184, v164, 0
    v_cvt_pk_bf16_f32 v185, 0, v164
    v_add_f32 v61, v61, v164
    v_cvt_pk_bf16_f32 v186, v165, 0
    v_cvt_pk_bf16_f32 v187, 0, v165
    v_add_f32 v61, v61, v165
    v_cvt_pk_bf16_f32 v188, v166, 0
    v_cvt_pk_bf16_f32 v189, 0, v166
    v_add_f32 v61, v61, v166
    v_cvt_pk_bf16_f32 v190, v167, 0
    v_cvt_pk_bf16_f32 v191, 0, v167
    v_add_f32 v61, v61, v167
    v_dot2c_f32_bf16_dpp v52, v176, v152 row_newbcast:0 row_mask:0xf bank_mask:0xf
    v_dot2c_f32_bf16_dpp v53, v177, v152 row_newbcast:0 row_mask:0xf bank_mask:0xf
    v_dot2c_f32_bf16_dpp v54, v176, v153 row_newbcast:0 row_mask:0xf bank_mask:0xf
    v_dot2c_f32_bf16_dpp v55, v177, v153 row_newbcast:0 row_mask:0xf bank_mask:0xf
    v_dot2c_f32_bf16_dpp v56, v176, v154 row_newbcast:0 row_mask:0xf bank_mask:0xf
    v_dot2c_f32_bf16_dpp v57, v177, v154 row_newbcast:0 row_mask:0xf bank_mask:0xf
    v_dot2c_f32_bf16_dpp v58, v176, v155 row_newbcast:0 row_mask:0xf bank_mask:0xf
    v_dot2c_f32_bf16_dpp v59, v177, v155 row_newbcast:0 row_mask:0xf bank_mask:0xf
    v_dot2c_f32_bf16_dpp v52, v176, v156 row_newbcast:8 row_mask:0xf bank_mask:0xf
    v_dot2c_f32_bf16_dpp v53, v177, v156 row_newbcast:8 row_mask:0xf bank_mask:0xf
    v_dot2c_f32_bf16_dpp v54, v176, v157 row_newbcast:8 row_mask:0xf bank_mask:0xf
    v_dot2c_f32_bf16_dpp v55, v177, v157 row_newbcast:8 row_mask:0xf bank_mask:0xf
    v_dot2c_f32_bf16_dpp v56, v176, v158 row_newbcast:8 row_mask:0xf bank_mask:0xf
    v_dot2c_f32_bf16_dpp v57, v177, v158 row_newbcast:8 row_mask:0xf bank_mask:0xf
    v_dot2c_f32_bf16_dpp v58, v176, v159 row_newbcast:8 row_mask:0xf bank_mask:0xf
    v_dot2c_f32_bf16_dpp v59, v177, v159 row_newbcast:8 row_mask:0xf bank_mask:0xf
    s_add_u32 s54, s48, 294912
    s_waitcnt vmcnt(3)
    buffer_load_dwordx4 v[104:107], v16, s[20:23], s54 offen offset:0 nt
    s_waitcnt vmcnt(3)
    buffer_load_dwordx4 v[108:111], v16, s[20:23], s54 offen offset:1024 nt
    s_add_u32 s54, s48, 344064
    s_waitcnt vmcnt(3)
    buffer_load_dwordx4 v[112:115], v16, s[20:23], s54 offen offset:0 nt
    s_waitcnt vmcnt(3)
    buffer_load_dwordx4 v[116:119], v16, s[20:23], s54 offen offset:1024 nt
    v_dot2c_f32_bf16_dpp v52, v178, v64 row_newbcast:0 row_mask:0xf bank_mask:0xf
    v_dot2c_f32_bf16_dpp v53, v179, v64 row_newbcast:0 row_mask:0xf bank_mask:0xf
    v_dot2c_f32_bf16_dpp v54, v178, v65 row_newbcast:0 row_mask:0xf bank_mask:0xf
    v_dot2c_f32_bf16_dpp v55, v179, v65 row_newbcast:0 row_mask:0xf bank_mask:0xf
    v_dot2c_f32_bf16_dpp v56, v178, v66 row_newbcast:0 row_mask:0xf bank_mask:0xf
    v_dot2c_f32_bf16_dpp v57, v179, v66 row_newbcast:0 row_mask:0xf bank_mask:0xf
    v_dot2c_f32_bf16_dpp v58, v178, v67 row_newbcast:0 row_mask:0xf bank_mask:0xf
    v_dot2c_f32_bf16_dpp v59, v179, v67 row_newbcast:0 row_mask:0xf bank_mask:0xf
    v_dot2c_f32_bf16_dpp v52, v178, v68 row_newbcast:8 row_mask:0xf bank_mask:0xf
    v_dot2c_f32_bf16_dpp v53, v179, v68 row_newbcast:8 row_mask:0xf bank_mask:0xf
    v_dot2c_f32_bf16_dpp v54, v178, v69 row_newbcast:8 row_mask:0xf bank_mask:0xf
    v_dot2c_f32_bf16_dpp v55, v179, v69 row_newbcast:8 row_mask:0xf bank_mask:0xf
    v_dot2c_f32_bf16_dpp v56, v178, v70 row_newbcast:8 row_mask:0xf bank_mask:0xf
    v_dot2c_f32_bf16_dpp v57, v179, v70 row_newbcast:8 row_mask:0xf bank_mask:0xf
    v_dot2c_f32_bf16_dpp v58, v178, v71 row_newbcast:8 row_mask:0xf bank_mask:0xf
    v_dot2c_f32_bf16_dpp v59, v179, v71 row_newbcast:8 row_mask:0xf bank_mask:0xf
    v_dot2c_f32_bf16_dpp v52, v180, v72 row_newbcast:0 row_mask:0xf bank_mask:0xf
    v_dot2c_f32_bf16_dpp v53, v181, v72 row_newbcast:0 row_mask:0xf bank_mask:0xf
    v_dot2c_f32_bf16_dpp v54, v180, v73 row_newbcast:0 row_mask:0xf bank_mask:0xf
    v_dot2c_f32_bf16_dpp v55, v181, v73 row_newbcast:0 row_mask:0xf bank_mask:0xf
    v_dot2c_f32_bf16_dpp v56, v180, v74 row_newbcast:0 row_mask:0xf bank_mask:0xf
    v_dot2c_f32_bf16_dpp v57, v181, v74 row_newbcast:0 row_mask:0xf bank_mask:0xf
    v_dot2c_f32_bf16_dpp v58, v180, v75 row_newbcast:0 row_mask:0xf bank_mask:0xf
    v_dot2c_f32_bf16_dpp v59, v181, v75 row_newbcast:0 row_mask:0xf bank_mask:0xf
    v_dot2c_f32_bf16_dpp v52, v180, v76 row_newbcast:8 row_mask:0xf bank_mask:0xf
    v_dot2c_f32_bf16_dpp v53, v181, v76 row_newbcast:8 row_mask:0xf bank_mask:0xf
    v_dot2c_f32_bf16_dpp v54, v180, v77 row_newbcast:8 row_mask:0xf bank_mask:0xf
    v_dot2c_f32_bf16_dpp v55, v181, v77 row_newbcast:8 row_mask:0xf bank_mask:0xf
    v_dot2c_f32_bf16_dpp v56, v180, v78 row_newbcast:8 row_mask:0xf bank_mask:0xf
    v_dot2c_f32_bf16_dpp v57, v181, v78 row_newbcast:8 row_mask:0xf bank_mask:0xf
    v_dot2c_f32_bf16_dpp v58, v180, v79 row_newbcast:8 row_mask:0xf bank_mask:0xf
    v_dot2c_f32_bf16_dpp v59, v181, v79 row_newbcast:8 row_mask:0xf bank_mask:0xf
    v_dot2c_f32_bf16_dpp v52, v182, v80 row_newbcast:0 row_mask:0xf bank_mask:0xf
    v_dot2c_f32_bf16_dpp v53, v183, v80 row_newbcast:0 row_mask:0xf bank_mask:0xf
    v_dot2c_f32_bf16_dpp v54, v182, v81 row_newbcast:0 row_mask:0xf bank_mask:0xf
    v_dot2c_f32_bf16_dpp v55, v183, v81 row_newbcast:0 row_mask:0xf bank_mask:0xf
    v_dot2c_f32_bf16_dpp v56, v182, v82 row_newbcast:0 row_mask:0xf bank_mask:0xf
    v_dot2c_f32_bf16_dpp v57, v183, v82 row_newbcast:0 row_mask:0xf bank_mask:0xf
    v_dot2c_f32_bf16_dpp v58, v182, v83 row_newbcast:0 row_mask:0xf bank_mask:0xf
    v_dot2c_f32_bf16_dpp v59, v183, v83 row_newbcast:0 row_mask:0xf bank_mask:0xf
    v_dot2c_f32_bf16_dpp v52, v182, v84 row_newbcast:8 row_mask:0xf bank_mask:0xf
    v_dot2c_f32_bf16_dpp v53, v183, v84 row_newbcast:8 row_mask:0xf bank_mask:0xf
    v_dot2c_f32_bf16_dpp v54, v182, v85 row_newbcast:8 row_mask:0xf bank_mask:0xf
    v_dot2c_f32_bf16_dpp v55, v183, v85 row_newbcast:8 row_mask:0xf bank_mask:0xf
    v_dot2c_f32_bf16_dpp v56, v182, v86 row_newbcast:8 row_mask:0xf bank_mask:0xf
    v_dot2c_f32_bf16_dpp v57, v183, v86 row_newbcast:8 row_mask:0xf bank_mask:0xf
    v_dot2c_f32_bf16_dpp v58, v182, v87 row_newbcast:8 row_mask:0xf bank_mask:0xf
    v_dot2c_f32_bf16_dpp v59, v183, v87 row_newbcast:8 row_mask:0xf bank_mask:0xf
    s_add_u32 s54, s48, 393216
    s_waitcnt vmcnt(3)
    buffer_load_dwordx4 v[120:123], v16, s[20:23], s54 offen offset:0 nt
    s_waitcnt vmcnt(3)
    buffer_load_dwordx4 v[124:127], v16, s[20:23], s54 offen offset:1024 nt
    s_add_u32 s54, s48, 442368
    s_waitcnt vmcnt(3)
    buffer_load_dwordx4 v[128:131], v16, s[20:23], s54 offen offset:0 nt
    s_waitcnt vmcnt(3)
    buffer_load_dwordx4 v[132:135], v16, s[20:23], s54 offen offset:1024 nt
    v_dot2c_f32_bf16_dpp v52, v184, v88 row_newbcast:0 row_mask:0xf bank_mask:0xf
    v_dot2c_f32_bf16_dpp v53, v185, v88 row_newbcast:0 row_mask:0xf bank_mask:0xf
    v_dot2c_f32_bf16_dpp v54, v184, v89 row_newbcast:0 row_mask:0xf bank_mask:0xf
    v_dot2c_f32_bf16_dpp v55, v185, v89 row_newbcast:0 row_mask:0xf bank_mask:0xf
    v_dot2c_f32_bf16_dpp v56, v184, v90 row_newbcast:0 row_mask:0xf bank_mask:0xf
    v_dot2c_f32_bf16_dpp v57, v185, v90 row_newbcast:0 row_mask:0xf bank_mask:0xf
    v_dot2c_f32_bf16_dpp v58, v184, v91 row_newbcast:0 row_mask:0xf bank_mask:0xf
    v_dot2c_f32_bf16_dpp v59, v185, v91 row_newbcast:0 row_mask:0xf bank_mask:0xf
    v_dot2c_f32_bf16_dpp v52, v184, v92 row_newbcast:8 row_mask:0xf bank_mask:0xf
    v_dot2c_f32_bf16_dpp v53, v185, v92 row_newbcast:8 row_mask:0xf bank_mask:0xf
    v_dot2c_f32_bf16_dpp v54, v184, v93 row_newbcast:8 row_mask:0xf bank_mask:0xf
    v_dot2c_f32_bf16_dpp v55, v185, v93 row_newbcast:8 row_mask:0xf bank_mask:0xf
    v_dot2c_f32_bf16_dpp v56, v184, v94 row_newbcast:8 row_mask:0xf bank_mask:0xf
    v_dot2c_f32_bf16_dpp v57, v185, v94 row_newbcast:8 row_mask:0xf bank_mask:0xf
    v_dot2c_f32_bf16_dpp v58, v184, v95 row_newbcast:8 row_mask:0xf bank_mask:0xf
    v_dot2c_f32_bf16_dpp v59, v185, v95 row_newbcast:8 row_mask:0xf bank_mask:0xf
    v_dot2c_f32_bf16_dpp v52, v186, v96 row_newbcast:0 row_mask:0xf bank_mask:0xf
    v_dot2c_f32_bf16_dpp v53, v187, v96 row_newbcast:0 row_mask:0xf bank_mask:0xf
    v_dot2c_f32_bf16_dpp v54, v186, v97 row_newbcast:0 row_mask:0xf bank_mask:0xf
    v_dot2c_f32_bf16_dpp v55, v187, v97 row_newbcast:0 row_mask:0xf bank_mask:0xf
    v_dot2c_f32_bf16_dpp v56, v186, v98 row_newbcast:0 row_mask:0xf bank_mask:0xf
    v_dot2c_f32_bf16_dpp v57, v187, v98 row_newbcast:0 row_mask:0xf bank_mask:0xf
    v_dot2c_f32_bf16_dpp v58, v186, v99 row_newbcast:0 row_mask:0xf bank_mask:0xf
    v_dot2c_f32_bf16_dpp v59, v187, v99 row_newbcast:0 row_mask:0xf bank_mask:0xf
    v_dot2c_f32_bf16_dpp v52, v186, v100 row_newbcast:8 row_mask:0xf bank_mask:0xf
    v_dot2c_f32_bf16_dpp v53, v187, v100 row_newbcast:8 row_mask:0xf bank_mask:0xf
    v_dot2c_f32_bf16_dpp v54, v186, v101 row_newbcast:8 row_mask:0xf bank_mask:0xf
    v_dot2c_f32_bf16_dpp v55, v187, v101 row_newbcast:8 row_mask:0xf bank_mask:0xf
    v_dot2c_f32_bf16_dpp v56, v186, v102 row_newbcast:8 row_mask:0xf bank_mask:0xf
    v_dot2c_f32_bf16_dpp v57, v187, v102 row_newbcast:8 row_mask:0xf bank_mask:0xf
    v_dot2c_f32_bf16_dpp v58, v186, v103 row_newbcast:8 row_mask:0xf bank_mask:0xf
    v_dot2c_f32_bf16_dpp v59, v187, v103 row_newbcast:8 row_mask:0xf bank_mask:0xf
    v_dot2c_f32_bf16_dpp v52, v188, v104 row_newbcast:0 row_mask:0xf bank_mask:0xf
    v_dot2c_f32_bf16_dpp v53, v189, v104 row_newbcast:0 row_mask:0xf bank_mask:0xf
    v_dot2c_f32_bf16_dpp v54, v188, v105 row_newbcast:0 row_mask:0xf bank_mask:0xf
    v_dot2c_f32_bf16_dpp v55, v189, v105 row_newbcast:0 row_mask:0xf bank_mask:0xf
    v_dot2c_f32_bf16_dpp v56, v188, v106 row_newbcast:0 row_mask:0xf bank_mask:0xf
    v_dot2c_f32_bf16_dpp v57, v189, v106 row_newbcast:0 row_mask:0xf bank_mask:0xf
    v_dot2c_f32_bf16_dpp v58, v188, v107 row_newbcast:0 row_mask:0xf bank_mask:0xf
    v_dot2c_f32_bf16_dpp v59, v189, v107 row_newbcast:0 row_mask:0xf bank_mask:0xf
    v_dot2c_f32_bf16_dpp v52, v188, v108 row_newbcast:8 row_mask:0xf bank_mask:0xf
    v_dot2c_f32_bf16_dpp v53, v189, v108 row_newbcast:8 row_mask:0xf bank_mask:0xf
    v_dot2c_f32_bf16_dpp v54, v188, v109 row_newbcast:8 row_mask:0xf bank_mask:0xf
    v_dot2c_f32_bf16_dpp v55, v189, v109 row_newbcast:8 row_mask:0xf bank_mask:0xf
    v_dot2c_f32_bf16_dpp v56, v188, v110 row_newbcast:8 row_mask:0xf bank_mask:0xf
    v_dot2c_f32_bf16_dpp v57, v189, v110 row_newbcast:8 row_mask:0xf bank_mask:0xf
    v_dot2c_f32_bf16_dpp v58, v188, v111 row_newbcast:8 row_mask:0xf bank_mask:0xf
    v_dot2c_f32_bf16_dpp v59, v189, v111 row_newbcast:8 row_mask:0xf bank_mask:0xf
    v_dot2c_f32_bf16_dpp v52, v190, v112 row_newbcast:0 row_mask:0xf bank_mask:0xf
    v_dot2c_f32_bf16_dpp v53, v191, v112 row_newbcast:0 row_mask:0xf bank_mask:0xf
    v_dot2c_f32_bf16_dpp v54, v190, v113 row_newbcast:0 row_mask:0xf bank_mask:0xf
    v_dot2c_f32_bf16_dpp v55, v191, v113 row_newbcast:0 row_mask:0xf bank_mask:0xf
    v_dot2c_f32_bf16_dpp v56, v190, v114 row_newbcast:0 row_mask:0xf bank_mask:0xf
    v_dot2c_f32_bf16_dpp v57, v191, v114 row_newbcast:0 row_mask:0xf bank_mask:0xf
    v_dot2c_f32_bf16_dpp v58, v190, v115 row_newbcast:0 row_mask:0xf bank_mask:0xf
    v_dot2c_f32_bf16_dpp v59, v191, v115 row_newbcast:0 row_mask:0xf bank_mask:0xf
    v_dot2c_f32_bf16_dpp v52, v190, v116 row_newbcast:8 row_mask:0xf bank_mask:0xf
    v_dot2c_f32_bf16_dpp v53, v191, v116 row_newbcast:8 row_mask:0xf bank_mask:0xf
    v_dot2c_f32_bf16_dpp v54, v190, v117 row_newbcast:8 row_mask:0xf bank_mask:0xf
    v_dot2c_f32_bf16_dpp v55, v191, v117 row_newbcast:8 row_mask:0xf bank_mask:0xf
    v_dot2c_f32_bf16_dpp v56, v190, v118 row_newbcast:8 row_mask:0xf bank_mask:0xf
    v_dot2c_f32_bf16_dpp v57, v191, v118 row_newbcast:8 row_mask:0xf bank_mask:0xf
    v_dot2c_f32_bf16_dpp v58, v190, v119 row_newbcast:8 row_mask:0xf bank_mask:0xf
    v_dot2c_f32_bf16_dpp v59, v191, v119 row_newbcast:8 row_mask:0xf bank_mask:0xf
    s_waitcnt lgkmcnt(0)
    s_barrier
    ds_read_b128 v[8:11], v43
    ds_read_b128 v[12:15], v43 offset:16
    s_waitcnt lgkmcnt(0)
    v_max3_f32 v60, v8, v9, v10
    v_max3_f32 v12, v12, v13, v14
    v_max3_f32 v60, v60, v11, v15
    v_max_f32 v60, v60, v12
    v_sub_f32 v34, v31, v60
    v_exp_f32 v34, v34
    s_nop 0
    v_mul_f32 v61, v61, v34
    v_pk_mul_f32 v[52:53], v[52:53], v[34:35] op_sel_hi:[1,0]
    v_pk_mul_f32 v[54:55], v[54:55], v[34:35] op_sel_hi:[1,0]
    v_pk_mul_f32 v[56:57], v[56:57], v[34:35] op_sel_hi:[1,0]
    v_pk_mul_f32 v[58:59], v[58:59], v[34:35] op_sel_hi:[1,0]
    v_fma_f32 v168, v168, s52, -v60
    v_fma_f32 v169, v169, s52, -v60
    v_exp_f32 v168, v168
    v_exp_f32 v169, v169
    v_cvt_pk_bf16_f32 v192, v168, 0
    v_cvt_pk_bf16_f32 v193, 0, v168
    v_add_f32 v61, v61, v168
    v_cvt_pk_bf16_f32 v194, v169, 0
    v_cvt_pk_bf16_f32 v195, 0, v169
    v_add_f32 v61, v61, v169
    s_nop 1
    v_add_f32_dpp v61, v61, v61 row_ror:8 row_mask:0xf bank_mask:0xf
    v_mov_b32 v32, v61
    s_nop 1
    v_permlane16_swap_b32 v32, v61
    v_add_f32 v61, v61, v32
    v_mov_b32 v32, v61
    s_nop 1
    v_permlane32_swap_b32 v32, v61
    v_add_f32 v61, v61, v32
    ds_write_b32 v39, v61 offset:32
    s_cmp_lg_u32 s3, 3
    s_cselect_b64 vcc, -1, 0
    s_cbranch_scc1 L_pe_4
    s_add_u32 m0, s47, 0
    s_nop 0
    buffer_load_dwordx4 v17, s[24:27], s46 offen nt lds
    s_add_u32 s46, s46, 8192
    s_add_u32 m0, s47, 1024
    s_nop 0
    buffer_load_dwordx4 v18, s[24:27], s46 offen nt lds
    s_add_u32 s46, s46, 8192
    s_add_u32 m0, s47, 2048
    s_nop 0
    buffer_load_dwordx4 v17, s[24:27], s46 offen nt lds
    s_add_u32 s46, s46, 8192
    s_add_u32 m0, s47, 3072
    s_nop 0
    buffer_load_dwordx4 v18, s[24:27], s46 offen nt lds
    s_add_u32 s46, s46, 8192
L_pe_4:
    s_waitcnt vmcnt(7)
    s_cbranch_vccz L_lw_5
    s_waitcnt vmcnt(3)
L_lw_5:
    v_dot2c_f32_bf16_dpp v52, v192, v120 row_newbcast:0 row_mask:0xf bank_mask:0xf
    v_dot2c_f32_bf16_dpp v53, v193, v120 row_newbcast:0 row_mask:0xf bank_mask:0xf
    v_dot2c_f32_bf16_dpp v54, v192, v121 row_newbcast:0 row_mask:0xf bank_mask:0xf
    v_dot2c_f32_bf16_dpp v55, v193, v121 row_newbcast:0 row_mask:0xf bank_mask:0xf
    v_dot2c_f32_bf16_dpp v56, v192, v122 row_newbcast:0 row_mask:0xf bank_mask:0xf
    v_dot2c_f32_bf16_dpp v57, v193, v122 row_newbcast:0 row_mask:0xf bank_mask:0xf
    v_dot2c_f32_bf16_dpp v58, v192, v123 row_newbcast:0 row_mask:0xf bank_mask:0xf
    v_dot2c_f32_bf16_dpp v59, v193, v123 row_newbcast:0 row_mask:0xf bank_mask:0xf
    s_waitcnt vmcnt(6)
    s_cbranch_vccz L_lw_6
    s_waitcnt vmcnt(2)
L_lw_6:
    v_dot2c_f32_bf16_dpp v52, v192, v124 row_newbcast:8 row_mask:0xf bank_mask:0xf
    v_dot2c_f32_bf16_dpp v53, v193, v124 row_newbcast:8 row_mask:0xf bank_mask:0xf
    v_dot2c_f32_bf16_dpp v54, v192, v125 row_newbcast:8 row_mask:0xf bank_mask:0xf
    v_dot2c_f32_bf16_dpp v55, v193, v125 row_newbcast:8 row_mask:0xf bank_mask:0xf
    v_dot2c_f32_bf16_dpp v56, v192, v126 row_newbcast:8 row_mask:0xf bank_mask:0xf
    v_dot2c_f32_bf16_dpp v57, v193, v126 row_newbcast:8 row_mask:0xf bank_mask:0xf
    v_dot2c_f32_bf16_dpp v58, v192, v127 row_newbcast:8 row_mask:0xf bank_mask:0xf
    v_dot2c_f32_bf16_dpp v59, v193, v127 row_newbcast:8 row_mask:0xf bank_mask:0xf
    s_waitcnt vmcnt(5)
    s_cbranch_vccz L_lw_7
    s_waitcnt vmcnt(1)
L_lw_7:
    v_dot2c_f32_bf16_dpp v52, v194, v128 row_newbcast:0 row_mask:0xf bank_mask:0xf
    v_dot2c_f32_bf16_dpp v53, v195, v128 row_newbcast:0 row_mask:0xf bank_mask:0xf
    v_dot2c_f32_bf16_dpp v54, v194, v129 row_newbcast:0 row_mask:0xf bank_mask:0xf
    v_dot2c_f32_bf16_dpp v55, v195, v129 row_newbcast:0 row_mask:0xf bank_mask:0xf
    v_dot2c_f32_bf16_dpp v56, v194, v130 row_newbcast:0 row_mask:0xf bank_mask:0xf
    v_dot2c_f32_bf16_dpp v57, v195, v130 row_newbcast:0 row_mask:0xf bank_mask:0xf
    v_dot2c_f32_bf16_dpp v58, v194, v131 row_newbcast:0 row_mask:0xf bank_mask:0xf
    v_dot2c_f32_bf16_dpp v59, v195, v131 row_newbcast:0 row_mask:0xf bank_mask:0xf
    s_waitcnt vmcnt(4)
    s_cbranch_vccz L_lw_8
    s_waitcnt vmcnt(0)
L_lw_8:
    v_dot2c_f32_bf16_dpp v52, v194, v132 row_newbcast:8 row_mask:0xf bank_mask:0xf
    v_dot2c_f32_bf16_dpp v53, v195, v132 row_newbcast:8 row_mask:0xf bank_mask:0xf
    v_dot2c_f32_bf16_dpp v54, v194, v133 row_newbcast:8 row_mask:0xf bank_mask:0xf
    v_dot2c_f32_bf16_dpp v55, v195, v133 row_newbcast:8 row_mask:0xf bank_mask:0xf
    v_dot2c_f32_bf16_dpp v56, v194, v134 row_newbcast:8 row_mask:0xf bank_mask:0xf
    v_dot2c_f32_bf16_dpp v57, v195, v134 row_newbcast:8 row_mask:0xf bank_mask:0xf
    v_dot2c_f32_bf16_dpp v58, v194, v135 row_newbcast:8 row_mask:0xf bank_mask:0xf
    v_dot2c_f32_bf16_dpp v59, v195, v135 row_newbcast:8 row_mask:0xf bank_mask:0xf
    s_branch L_afin
L_acommon:
    s_add_u32 s54, s48, 98304
    s_waitcnt vmcnt(3)
    buffer_load_dwordx4 v[88:91], v16, s[16:19], s54 offen offset:0 nt
    s_waitcnt vmcnt(3)
    buffer_load_dwordx4 v[92:95], v16, s[16:19], s54 offen offset:1024 nt
    s_add_u32 s54, s48, 147456
    s_waitcnt vmcnt(3)
    buffer_load_dwordx4 v[96:99], v16, s[16:19], s54 offen offset:0 nt
    s_waitcnt vmcnt(3)
    buffer_load_dwordx4 v[100:103], v16, s[16:19], s54 offen offset:1024 nt
    s_load_dwordx2 s[28:29], s[0:1], 88
    v_lshrrev_b32 v9, 2, v1
    v_lshlrev_b32 v7, 10, v2
    v_lshl_add_u32 v7, v9, 7, v7
    v_and_b32 v10, 3, v0
    v_lshl_add_u32 v7, v10, 3, v7
    v_lshrrev_b32 v9, 1, v9
    v_and_b32 v8, 1, v2
    v_lshl_or_b32 v9, v8, 1, v9
    s_and_b32 s33, s3, 3
    v_xor_b32 v9, s33, v9
    v_lshl_add_u32 v7, v9, 5, v7
    s_cmp_lt_u32 s3, 4
    s_mov_b32 s36, 114688
    s_cmov_b32 s36, 81920
    s_mov_b32 s40, 524288
    s_cmov_b32 s40, 393216
    v_add_u32 v244, s36, v7
    s_lshl_b32 s36, s4, 12
    s_add_u32 s40, s40, s36
    s_lshl_b32 s36, s33, 9
    s_add_u32 s40, s40, s36
    v_lshrrev_b32 v9, 5, v0
    v_mul_u32_u24 v245, 1536, v9
    v_add_u32 v245, v245, v16
    s_and_b32 s36, s3, 4
    s_lshl_b32 s36, s36, 1
    s_add_u32 s33, s36, s33
    v_lshl_add_u32 v9, v9, 2, s33
    v_and_b32 v8, 31, v0
    v_mul_u32_u24 v246, 272, v9
    v_lshl_add_u32 v246, v8, 3, v246
    v_add_u32 v246, 151552, v246
    v_mul_u32_u24 v247, 136, v9
    v_lshl_add_u32 v247, v8, 2, v247
    v_add_u32 v247, 156160, v247
    v_and_b32 v9, 7, v0
    v_add_u32 v9, s36, v9
    v_mul_u32_u24 v248, 272, v9
    v_lshl_add_u32 v248, v2, 4, v248
    v_add_u32 v248, 151552, v248
    v_mul_u32_u24 v249, 136, v9
    v_add_u32 v249, 156160, v249
    v_mov_b32 v240, 0
    v_mov_b32 v241, 0
    v_and_b32 v8, 1, v0
    v_add_u32 v8, -1, v8
    v_and_b32 v242, 0xff7fffff, v8
    s_mov_b32 s30, 4096
    s_mov_b32 s31, 0x20000
    v_lshlrev_b32 v250, 12, v2
    v_lshl_add_u32 v250, v1, 2, v250
    s_cmp_lt_u32 s3, 4
    s_cselect_b32 s41, 0, 0
    s_xor_b32 s41, s41, s5
    s_lshl_b32 s41, s41, 3
    s_add_u32 s41, s41, s3
    s_lshr_b32 s41, s41, 1
    s_lshl_b32 s41, s41, 13
    s_and_b32 s36, s3, 1
    s_lshl_b32 s36, s36, 6
    s_add_u32 s41, s41, s36
    v_mov_b32 v251, 0xff
    s_lshl_b32 s36, s4, 7
    s_add_u32 s41, s41, s36
    s_add_u32 s41, s41, 4194304
    v_mov_b32 v253, s32
    s_xor_b32 s38, s5, 0
    s_lshl_b32 s42, s38, 2
    s_lshr_b32 s36, s4, 3
    s_add_u32 s42, s42, s36
    s_lshl_b32 s42, s42, 1
    s_bfe_u32 s36, s4, 0x10001
    s_add_u32 s42, s42, s36
    s_lshl_b32 s42, s42, 12
    s_and_b32 s33, s4, 1
    s_lshl_b32 s43, s33, 6
    s_add_u32 s42, s42, s43
    s_add_u32 s42, s42, 4194304
    s_lshl_b32 s43, s33, 4
    s_and_b32 s36, s36, 1
    s_lshl_b32 s36, s36, 11
    s_add_u32 s43, s43, s36
    s_lshr_b32 s36, s4, 4
    s_lshl_b32 s36, s36, 10
    s_add_u32 s43, s43, s36
    s_lshl_b32 s36, s38, 7
    s_add_u32 s43, s43, s36
    s_bfe_u32 s36, s4, 0x20002
    s_lshl_b32 s36, s36, 5
    s_add_u32 s43, s43, s36
    v_lshlrev_b32 v254, 3, v0
    v_mov_b32 v8, s5
    v_mov_b32 v9, v0
    s_sub_u32 s59, s6, 1
    s_not_b32 s58, s59
    s_cmp_eq_u32 s3, s7
    s_cselect_b64 s[58:59], s[58:59], -1
    v_mul_u32_u24 v238, 272, v8
    v_lshl_add_u32 v238, v9, 3, v238
    v_add_u32 v238, 151552, v238
    v_mul_u32_u24 v239, 136, v8
    v_lshl_add_u32 v239, v9, 2, v239
    v_add_u32 v239, 156160, v239
    s_add_u32 s54, s48, 196608
    s_waitcnt vmcnt(3)
    buffer_load_dwordx4 v[104:107], v16, s[16:19], s54 offen offset:0 nt
    s_waitcnt vmcnt(3)
    buffer_load_dwordx4 v[108:111], v16, s[16:19], s54 offen offset:1024 nt
    s_add_u32 s54, s48, 245760
    s_waitcnt vmcnt(3)
    buffer_load_dwordx4 v[112:115], v16, s[16:19], s54 offen offset:0 nt
    s_waitcnt vmcnt(3)
    buffer_load_dwordx4 v[116:119], v16, s[16:19], s54 offen offset:1024 nt
    buffer_load_dwordx4 v[20:23], v16, s[12:15], s51 offen
    buffer_load_dwordx4 v[24:27], v16, s[12:15], s51 offen offset:1024
    s_add_u32 s54, s48, 294912
    s_waitcnt vmcnt(5)
    buffer_load_dwordx4 v[120:123], v16, s[16:19], s54 offen offset:0 nt
    s_waitcnt vmcnt(5)
    buffer_load_dwordx4 v[124:127], v16, s[16:19], s54 offen offset:1024 nt
    s_add_u32 s54, s48, 344064
    s_waitcnt vmcnt(5)
    buffer_load_dwordx4 v[128:131], v16, s[16:19], s54 offen offset:0 nt
    s_waitcnt vmcnt(5)
    buffer_load_dwordx4 v[132:135], v16, s[16:19], s54 offen offset:1024 nt
    s_mov_b32 s37, 262144
    s_waitcnt vmcnt(4)
L_qlp_9:
    v_bitop3_b32 v8, v23, v27, s32 bitop3:0x7e
    v_cmp_ne_u32 vcc, 0, v8
    s_cbranch_vccz L_qok_10
    s_sub_u32 s37, s37, 1
    s_cbranch_scc1 L_qok_10
    buffer_load_dwordx4 v[20:23], v16, s[12:15], s51 offen sc1
    buffer_load_dwordx4 v[24:27], v16, s[12:15], s51 offen offset:1024 sc1
    s_waitcnt vmcnt(0)
    s_branch L_qlp_9
L_qok_10:
    v_lshlrev_b32 v8, 16, v20
    v_and_b32 v9, 0xffff0000, v20
    v_lshlrev_b32 v10, 16, v21
    v_and_b32 v11, 0xffff0000, v21
    v_lshlrev_b32 v20, 16, v24
    v_and_b32 v21, 0xffff0000, v24
    v_lshlrev_b32 v22, 16, v25
    v_and_b32 v23, 0xffff0000, v25
    v_pk_add_f32 v[8:9], v[8:9], v[20:21]
    v_pk_add_f32 v[10:11], v[10:11], v[22:23]
    s_nop 1
    v_permlane32_swap_b32 v8, v10
    v_permlane32_swap_b32 v9, v11
    v_pk_add_f32 v[8:9], v[8:9], v[10:11]
    v_cvt_pk_bf16_f32 v20, v8, v9
    ds_write_b32 v36, v20
    ds_read_b128 v[24:27], v37
    s_waitcnt lgkmcnt(0)
    v_mov_b32 v28, 0
    v_mov_b32 v29, 0
    v_dot2c_f32_bf16 v28, v72, v24
    v_dot2c_f32_bf16 v29, v76, v24
    v_dot2c_f32_bf16 v28, v73, v25
    v_dot2c_f32_bf16 v29, v77, v25
    v_dot2c_f32_bf16 v28, v74, v26
    v_dot2c_f32_bf16 v29, v78, v26
    v_dot2c_f32_bf16 v28, v75, v27
    v_dot2c_f32_bf16 v29, v79, v27
    s_nop 1
    v_add_f32_dpp v160, v28, v28 row_ror:8 row_mask:0xf bank_mask:0x3
    v_add_f32_dpp v160, v29, v29 row_ror:8 row_mask:0xf bank_mask:0xc
    s_nop 1
    v_add_f32_dpp v160, v160, v160 row_half_mirror row_mask:0xf bank_mask:0xf
    s_nop 1
    v_add_f32_dpp v160, v160, v160 quad_perm:[1,0,3,2] row_mask:0xf bank_mask:0xf
    s_nop 1
    v_add_f32_dpp v160, v160, v160 quad_perm:[2,3,0,1] row_mask:0xf bank_mask:0xf
    v_mov_b32 v28, 0
    v_mov_b32 v29, 0
    v_dot2c_f32_bf16 v28, v80, v24
    v_dot2c_f32_bf16 v29, v84, v24
    v_dot2c_f32_bf16 v28, v81, v25
    v_dot2c_f32_bf16 v29, v85, v25
    v_dot2c_f32_bf16 v28, v82, v26
    v_dot2c_f32_bf16 v29, v86, v26
    v_dot2c_f32_bf16 v28, v83, v27
    v_dot2c_f32_bf16 v29, v87, v27
    s_nop 1
    v_add_f32_dpp v161, v28, v28 row_ror:8 row_mask:0xf bank_mask:0x3
    v_add_f32_dpp v161, v29, v29 row_ror:8 row_mask:0xf bank_mask:0xc
    s_nop 1
    v_add_f32_dpp v161, v161, v161 row_half_mirror row_mask:0xf bank_mask:0xf
    s_nop 1
    v_add_f32_dpp v161, v161, v161 quad_perm:[1,0,3,2] row_mask:0xf bank_mask:0xf
    s_nop 1
    v_add_f32_dpp v161, v161, v161 quad_perm:[2,3,0,1] row_mask:0xf bank_mask:0xf
    s_add_u32 s54, s48, 393216
    s_waitcnt vmcnt(3)
    buffer_load_dwordx4 v[136:139], v16, s[16:19], s54 offen offset:0 nt
    s_waitcnt vmcnt(3)
    buffer_load_dwordx4 v[140:143], v16, s[16:19], s54 offen offset:1024 nt
    s_add_u32 s54, s48, 442368
    s_waitcnt vmcnt(3)
    buffer_load_dwordx4 v[144:147], v16, s[16:19], s54 offen offset:0 nt
    s_waitcnt vmcnt(3)
    buffer_load_dwordx4 v[148:151], v16, s[16:19], s54 offen offset:1024 nt
    v_mov_b32 v28, 0
    v_mov_b32 v29, 0
    v_dot2c_f32_bf16 v28, v88, v24
    v_dot2c_f32_bf16 v29, v92, v24
    v_dot2c_f32_bf16 v28, v89, v25
    v_dot2c_f32_bf16 v29, v93, v25
    v_dot2c_f32_bf16 v28, v90, v26
    v_dot2c_f32_bf16 v29, v94, v26
    v_dot2c_f32_bf16 v28, v91, v27
    v_dot2c_f32_bf16 v29, v95, v27
    s_nop 1
    v_add_f32_dpp v162, v28, v28 row_ror:8 row_mask:0xf bank_mask:0x3
    v_add_f32_dpp v162, v29, v29 row_ror:8 row_mask:0xf bank_mask:0xc
    s_nop 1
    v_add_f32_dpp v162, v162, v162 row_half_mirror row_mask:0xf bank_mask:0xf
    s_nop 1
    v_add_f32_dpp v162, v162, v162 quad_perm:[1,0,3,2] row_mask:0xf bank_mask:0xf
    s_nop 1
    v_add_f32_dpp v162, v162, v162 quad_perm:[2,3,0,1] row_mask:0xf bank_mask:0xf
    v_mov_b32 v28, 0
    v_mov_b32 v29, 0
    v_dot2c_f32_bf16 v28, v96, v24
    v_dot2c_f32_bf16 v29, v100, v24
    v_dot2c_f32_bf16 v28, v97, v25
    v_dot2c_f32_bf16 v29, v101, v25
    v_dot2c_f32_bf16 v28, v98, v26
    v_dot2c_f32_bf16 v29, v102, v26
    v_dot2c_f32_bf16 v28, v99, v27
    v_dot2c_f32_bf16 v29, v103, v27
    s_nop 1
    v_add_f32_dpp v163, v28, v28 row_ror:8 row_mask:0xf bank_mask:0x3
    v_add_f32_dpp v163, v29, v29 row_ror:8 row_mask:0xf bank_mask:0xc
    s_nop 1
    v_add_f32_dpp v163, v163, v163 row_half_mirror row_mask:0xf bank_mask:0xf
    s_nop 1
    v_add_f32_dpp v163, v163, v163 quad_perm:[1,0,3,2] row_mask:0xf bank_mask:0xf
    s_nop 1
    v_add_f32_dpp v163, v163, v163 quad_perm:[2,3,0,1] row_mask:0xf bank_mask:0xf
    v_mov_b32 v28, 0
    v_mov_b32 v29, 0
    v_dot2c_f32_bf16 v28, v104, v24
    v_dot2c_f32_bf16 v29, v108, v24
    v_dot2c_f32_bf16 v28, v105, v25
    v_dot2c_f32_bf16 v29, v109, v25
    v_dot2c_f32_bf16 v28, v106, v26
    v_dot2c_f32_bf16 v29, v110, v26
    v_dot2c_f32_bf16 v28, v107, v27
    v_dot2c_f32_bf16 v29, v111, v27
    s_nop 1
    v_add_f32_dpp v164, v28, v28 row_ror:8 row_mask:0xf bank_mask:0x3
    v_add_f32_dpp v164, v29, v29 row_ror:8 row_mask:0xf bank_mask:0xc
    s_nop 1
    v_add_f32_dpp v164, v164, v164 row_half_mirror row_mask:0xf bank_mask:0xf
    s_nop 1
    v_add_f32_dpp v164, v164, v164 quad_perm:[1,0,3,2] row_mask:0xf bank_mask:0xf
    s_nop 1
    v_add_f32_dpp v164, v164, v164 quad_perm:[2,3,0,1] row_mask:0xf bank_mask:0xf
    s_add_u32 s54, s48, 491520
    s_waitcnt vmcnt(3)
    buffer_load_dwordx4 v[152:155], v16, s[16:19], s54 offen offset:0 nt
    s_waitcnt vmcnt(3)
    buffer_load_dwordx4 v[156:159], v16, s[16:19], s54 offen offset:1024 nt
    s_add_u32 s54, s48, 0
    s_waitcnt vmcnt(3)
    buffer_load_dwordx4 v[64:67], v16, s[20:23], s54 offen offset:0 nt
    s_waitcnt vmcnt(3)
    buffer_load_dwordx4 v[68:71], v16, s[20:23], s54 offen offset:1024 nt
    v_mov_b32 v28, 0
    v_mov_b32 v29, 0
    v_dot2c_f32_bf16 v28, v112, v24
    v_dot2c_f32_bf16 v29, v116, v24
    v_dot2c_f32_bf16 v28, v113, v25
    v_dot2c_f32_bf16 v29, v117, v25
    v_dot2c_f32_bf16 v28, v114, v26
    v_dot2c_f32_bf16 v29, v118, v26
    v_dot2c_f32_bf16 v28, v115, v27
    v_dot2c_f32_bf16 v29, v119, v27
    s_nop 1
    v_add_f32_dpp v165, v28, v28 row_ror:8 row_mask:0xf bank_mask:0x3
    v_add_f32_dpp v165, v29, v29 row_ror:8 row_mask:0xf bank_mask:0xc
    s_nop 1
    v_add_f32_dpp v165, v165, v165 row_half_mirror row_mask:0xf bank_mask:0xf
    s_nop 1
    v_add_f32_dpp v165, v165, v165 quad_perm:[1,0,3,2] row_mask:0xf bank_mask:0xf
    s_nop 1
    v_add_f32_dpp v165, v165, v165 quad_perm:[2,3,0,1] row_mask:0xf bank_mask:0xf
    v_mov_b32 v28, 0
    v_mov_b32 v29, 0
    v_dot2c_f32_bf16 v28, v120, v24
    v_dot2c_f32_bf16 v29, v124, v24
    v_dot2c_f32_bf16 v28, v121, v25
    v_dot2c_f32_bf16 v29, v125, v25
    v_dot2c_f32_bf16 v28, v122, v26
    v_dot2c_f32_bf16 v29, v126, v26
    v_dot2c_f32_bf16 v28, v123, v27
    v_dot2c_f32_bf16 v29, v127, v27
    s_nop 1
    v_add_f32_dpp v166, v28, v28 row_ror:8 row_mask:0xf bank_mask:0x3
    v_add_f32_dpp v166, v29, v29 row_ror:8 row_mask:0xf bank_mask:0xc
    s_nop 1
    v_add_f32_dpp v166, v166, v166 row_half_mirror row_mask:0xf bank_mask:0xf
    s_nop 1
    v_add_f32_dpp v166, v166, v166 quad_perm:[1,0,3,2] row_mask:0xf bank_mask:0xf
    s_nop 1
    v_add_f32_dpp v166, v166, v166 quad_perm:[2,3,0,1] row_mask:0xf bank_mask:0xf
    v_mov_b32 v28, 0
    v_mov_b32 v29, 0
    v_dot2c_f32_bf16 v28, v128, v24
    v_dot2c_f32_bf16 v29, v132, v24
    v_dot2c_f32_bf16 v28, v129, v25
    v_dot2c_f32_bf16 v29, v133, v25
    v_dot2c_f32_bf16 v28, v130, v26
    v_dot2c_f32_bf16 v29, v134, v26
    v_dot2c_f32_bf16 v28, v131, v27
    v_dot2c_f32_bf16 v29, v135, v27
    s_nop 1
    v_add_f32_dpp v167, v28, v28 row_ror:8 row_mask:0xf bank_mask:0x3
    v_add_f32_dpp v167, v29, v29 row_ror:8 row_mask:0xf bank_mask:0xc
    s_nop 1
    v_add_f32_dpp v167, v167, v167 row_half_mirror row_mask:0xf bank_mask:0xf
    s_nop 1
    v_add_f32_dpp v167, v167, v167 quad_perm:[1,0,3,2] row_mask:0xf bank_mask:0xf
    s_nop 1
    v_add_f32_dpp v167, v167, v167 quad_perm:[2,3,0,1] row_mask:0xf bank_mask:0xf
    s_add_u32 s54, s48, 49152
    s_waitcnt vmcnt(3)
    buffer_load_dwordx4 v[72:75], v16, s[20:23], s54 offen offset:0 nt
    s_waitcnt vmcnt(3)
    buffer_load_dwordx4 v[76:79], v16, s[20:23], s54 offen offset:1024 nt
    s_add_u32 s54, s48, 98304
    s_waitcnt vmcnt(3)
    buffer_load_dwordx4 v[80:83], v16, s[20:23], s54 offen offset:0 nt
    s_waitcnt vmcnt(3)
    buffer_load_dwordx4 v[84:87], v16, s[20:23], s54 offen offset:1024 nt
    v_mov_b32 v28, 0
    v_mov_b32 v29, 0
    v_dot2c_f32_bf16 v28, v136, v24
    v_dot2c_f32_bf16 v29, v140, v24
    v_dot2c_f32_bf16 v28, v137, v25
    v_dot2c_f32_bf16 v29, v141, v25
    v_dot2c_f32_bf16 v28, v138, v26
    v_dot2c_f32_bf16 v29, v142, v26
    v_dot2c_f32_bf16 v28, v139, v27
    v_dot2c_f32_bf16 v29, v143, v27
    s_nop 1
    v_add_f32_dpp v168, v28, v28 row_ror:8 row_mask:0xf bank_mask:0x3
    v_add_f32_dpp v168, v29, v29 row_ror:8 row_mask:0xf bank_mask:0xc
    s_nop 1
    v_add_f32_dpp v168, v168, v168 row_half_mirror row_mask:0xf bank_mask:0xf
    s_nop 1
    v_add_f32_dpp v168, v168, v168 quad_perm:[1,0,3,2] row_mask:0xf bank_mask:0xf
    s_nop 1
    v_add_f32_dpp v168, v168, v168 quad_perm:[2,3,0,1] row_mask:0xf bank_mask:0xf
    v_mov_b32 v28, 0
    v_mov_b32 v29, 0
    v_dot2c_f32_bf16 v28, v144, v24
    v_dot2c_f32_bf16 v29, v148, v24
    v_dot2c_f32_bf16 v28, v145, v25
    v_dot2c_f32_bf16 v29, v149, v25
    v_dot2c_f32_bf16 v28, v146, v26
    v_dot2c_f32_bf16 v29, v150, v26
    v_dot2c_f32_bf16 v28, v147, v27
    v_dot2c_f32_bf16 v29, v151, v27
    s_nop 1
    v_add_f32_dpp v169, v28, v28 row_ror:8 row_mask:0xf bank_mask:0x3
    v_add_f32_dpp v169, v29, v29 row_ror:8 row_mask:0xf bank_mask:0xc
    s_nop 1
    v_add_f32_dpp v169, v169, v169 row_half_mirror row_mask:0xf bank_mask:0xf
    s_nop 1
    v_add_f32_dpp v169, v169, v169 quad_perm:[1,0,3,2] row_mask:0xf bank_mask:0xf
    s_nop 1
    v_add_f32_dpp v169, v169, v169 quad_perm:[2,3,0,1] row_mask:0xf bank_mask:0xf
    v_mov_b32 v28, 0
    v_mov_b32 v29, 0
    v_dot2c_f32_bf16 v28, v152, v24
    v_dot2c_f32_bf16 v29, v156, v24
    v_dot2c_f32_bf16 v28, v153, v25
    v_dot2c_f32_bf16 v29, v157, v25
    v_dot2c_f32_bf16 v28, v154, v26
    v_dot2c_f32_bf16 v29, v158, v26
    v_dot2c_f32_bf16 v28, v155, v27
    v_dot2c_f32_bf16 v29, v159, v27
    s_nop 1
    v_add_f32_dpp v170, v28, v28 row_ror:8 row_mask:0xf bank_mask:0x3
    v_add_f32_dpp v170, v29, v29 row_ror:8 row_mask:0xf bank_mask:0xc
    s_nop 1
    v_add_f32_dpp v170, v170, v170 row_half_mirror row_mask:0xf bank_mask:0xf
    s_nop 1
    v_add_f32_dpp v170, v170, v170 quad_perm:[1,0,3,2] row_mask:0xf bank_mask:0xf
    s_nop 1
    v_add_f32_dpp v170, v170, v170 quad_perm:[2,3,0,1] row_mask:0xf bank_mask:0xf
    v_max_f32 v31, v160, v170
    v_max3_f32 v31, v31, v161, v162
    v_max3_f32 v31, v31, v163, v164
    v_max3_f32 v31, v31, v165, v166
    v_max3_f32 v31, v31, v167, v168
    v_max3_f32 v31, v31, v169, v170
    s_nop 1
    v_max_f32_dpp v31, v31, v31 row_ror:8 row_mask:0xf bank_mask:0xf
    v_mov_b32 v32, v31
    s_nop 1
    v_permlane16_swap_b32 v32, v31
    v_max_f32 v31, v31, v32
    v_mov_b32 v32, v31
    s_nop 1
    v_permlane32_swap_b32 v32, v31
    v_max_f32 v31, v31, v32
    v_mul_f32 v31, s52, v31
    ds_write_b32 v39, v31
    s_add_u32 s54, s48, 147456
    s_waitcnt vmcnt(3)
    buffer_load_dwordx4 v[88:91], v16, s[20:23], s54 offen offset:0 nt
    s_waitcnt vmcnt(3)
    buffer_load_dwordx4 v[92:95], v16, s[20:23], s54 offen offset:1024 nt
    s_add_u32 s54, s48, 196608
    s_waitcnt vmcnt(3)
    buffer_load_dwordx4 v[96:99], v16, s[20:23], s54 offen offset:0 nt
    s_waitcnt vmcnt(3)
    buffer_load_dwordx4 v[100:103], v16, s[20:23], s54 offen offset:1024 nt
    v_fma_f32 v160, v160, s52, -v31
    v_fma_f32 v161, v161, s52, -v31
    v_fma_f32 v162, v162, s52, -v31
    v_fma_f32 v163, v163, s52, -v31
    v_fma_f32 v164, v164, s52, -v31
    v_fma_f32 v165, v165, s52, -v31
    v_fma_f32 v166, v166, s52, -v31
    v_fma_f32 v167, v167, s52, -v31
    v_fma_f32 v168, v168, s52, -v31
    v_exp_f32 v160, v160
    v_exp_f32 v161, v161
    v_exp_f32 v162, v162
    v_exp_f32 v163, v163
    v_exp_f32 v164, v164
    v_exp_f32 v165, v165
    v_exp_f32 v166, v166
    v_exp_f32 v167, v167
    v_exp_f32 v168, v168
    v_cvt_pk_bf16_f32 v176, v160, 0
    v_cvt_pk_bf16_f32 v177, 0, v160
    v_add_f32 v61, v61, v160
    v_cvt_pk_bf16_f32 v178, v161, 0
    v_cvt_pk_bf16_f32 v179, 0, v161
    v_add_f32 v61, v61, v161
    v_cvt_pk_bf16_f32 v180, v162, 0
    v_cvt_pk_bf16_f32 v181, 0, v162
    v_add_f32 v61, v61, v162
    v_cvt_pk_bf16_f32 v182, v163, 0
    v_cvt_pk_bf16_f32 v183, 0, v163
    v_add_f32 v61, v61, v163
    v_cvt_pk_bf16_f32 v184, v164, 0
    v_cvt_pk_bf16_f32 v185, 0, v164
    v_add_f32 v61, v61, v164
    v_cvt_pk_bf16_f32 v186, v165, 0
    v_cvt_pk_bf16_f32 v187, 0, v165
    v_add_f32 v61, v61, v165
    v_cvt_pk_bf16_f32 v188, v166, 0
    v_cvt_pk_bf16_f32 v189, 0, v166
    v_add_f32 v61, v61, v166
    v_cvt_pk_bf16_f32 v190, v167, 0
    v_cvt_pk_bf16_f32 v191, 0, v167
    v_add_f32 v61, v61, v167
    v_cvt_pk_bf16_f32 v192, v168, 0
    v_cvt_pk_bf16_f32 v193, 0, v168
    v_add_f32 v61, v61, v168
    v_dot2c_f32_bf16_dpp v52, v176, v64 row_newbcast:0 row_mask:0xf bank_mask:0xf
    v_dot2c_f32_bf16_dpp v53, v177, v64 row_newbcast:0 row_mask:0xf bank_mask:0xf
    v_dot2c_f32_bf16_dpp v54, v176, v65 row_newbcast:0 row_mask:0xf bank_mask:0xf
    v_dot2c_f32_bf16_dpp v55, v177, v65 row_newbcast:0 row_mask:0xf bank_mask:0xf
    v_dot2c_f32_bf16_dpp v56, v176, v66 row_newbcast:0 row_mask:0xf bank_mask:0xf
    v_dot2c_f32_bf16_dpp v57, v177, v66 row_newbcast:0 row_mask:0xf bank_mask:0xf
    v_dot2c_f32_bf16_dpp v58, v176, v67 row_newbcast:0 row_mask:0xf bank_mask:0xf
    v_dot2c_f32_bf16_dpp v59, v177, v67 row_newbcast:0 row_mask:0xf bank_mask:0xf
    v_dot2c_f32_bf16_dpp v52, v176, v68 row_newbcast:8 row_mask:0xf bank_mask:0xf
    v_dot2c_f32_bf16_dpp v53, v177, v68 row_newbcast:8 row_mask:0xf bank_mask:0xf
    v_dot2c_f32_bf16_dpp v54, v176, v69 row_newbcast:8 row_mask:0xf bank_mask:0xf
    v_dot2c_f32_bf16_dpp v55, v177, v69 row_newbcast:8 row_mask:0xf bank_mask:0xf
    v_dot2c_f32_bf16_dpp v56, v176, v70 row_newbcast:8 row_mask:0xf bank_mask:0xf
    v_dot2c_f32_bf16_dpp v57, v177, v70 row_newbcast:8 row_mask:0xf bank_mask:0xf
    v_dot2c_f32_bf16_dpp v58, v176, v71 row_newbcast:8 row_mask:0xf bank_mask:0xf
    v_dot2c_f32_bf16_dpp v59, v177, v71 row_newbcast:8 row_mask:0xf bank_mask:0xf
    s_add_u32 s54, s48, 245760
    s_waitcnt vmcnt(3)
    buffer_load_dwordx4 v[104:107], v16, s[20:23], s54 offen offset:0 nt
    s_waitcnt vmcnt(3)
    buffer_load_dwordx4 v[108:111], v16, s[20:23], s54 offen offset:1024 nt
    s_add_u32 s54, s48, 294912
    s_waitcnt vmcnt(3)
    buffer_load_dwordx4 v[112:115], v16, s[20:23], s54 offen offset:0 nt
    s_waitcnt vmcnt(3)
    buffer_load_dwordx4 v[116:119], v16, s[20:23], s54 offen offset:1024 nt
    v_dot2c_f32_bf16_dpp v52, v178, v72 row_newbcast:0 row_mask:0xf bank_mask:0xf
    v_dot2c_f32_bf16_dpp v53, v179, v72 row_newbcast:0 row_mask:0xf bank_mask:0xf
    v_dot2c_f32_bf16_dpp v54, v178, v73 row_newbcast:0 row_mask:0xf bank_mask:0xf
    v_dot2c_f32_bf16_dpp v55, v179, v73 row_newbcast:0 row_mask:0xf bank_mask:0xf
    v_dot2c_f32_bf16_dpp v56, v178, v74 row_newbcast:0 row_mask:0xf bank_mask:0xf
    v_dot2c_f32_bf16_dpp v57, v179, v74 row_newbcast:0 row_mask:0xf bank_mask:0xf
    v_dot2c_f32_bf16_dpp v58, v178, v75 row_newbcast:0 row_mask:0xf bank_mask:0xf
    v_dot2c_f32_bf16_dpp v59, v179, v75 row_newbcast:0 row_mask:0xf bank_mask:0xf
    v_dot2c_f32_bf16_dpp v52, v178, v76 row_newbcast:8 row_mask:0xf bank_mask:0xf
    v_dot2c_f32_bf16_dpp v53, v179, v76 row_newbcast:8 row_mask:0xf bank_mask:0xf
    v_dot2c_f32_bf16_dpp v54, v178, v77 row_newbcast:8 row_mask:0xf bank_mask:0xf
    v_dot2c_f32_bf16_dpp v55, v179, v77 row_newbcast:8 row_mask:0xf bank_mask:0xf
    v_dot2c_f32_bf16_dpp v56, v178, v78 row_newbcast:8 row_mask:0xf bank_mask:0xf
    v_dot2c_f32_bf16_dpp v57, v179, v78 row_newbcast:8 row_mask:0xf bank_mask:0xf
    v_dot2c_f32_bf16_dpp v58, v178, v79 row_newbcast:8 row_mask:0xf bank_mask:0xf
    v_dot2c_f32_bf16_dpp v59, v179, v79 row_newbcast:8 row_mask:0xf bank_mask:0xf
    v_dot2c_f32_bf16_dpp v52, v180, v80 row_newbcast:0 row_mask:0xf bank_mask:0xf
    v_dot2c_f32_bf16_dpp v53, v181, v80 row_newbcast:0 row_mask:0xf bank_mask:0xf
    v_dot2c_f32_bf16_dpp v54, v180, v81 row_newbcast:0 row_mask:0xf bank_mask:0xf
    v_dot2c_f32_bf16_dpp v55, v181, v81 row_newbcast:0 row_mask:0xf bank_mask:0xf
    v_dot2c_f32_bf16_dpp v56, v180, v82 row_newbcast:0 row_mask:0xf bank_mask:0xf
    v_dot2c_f32_bf16_dpp v57, v181, v82 row_newbcast:0 row_mask:0xf bank_mask:0xf
    v_dot2c_f32_bf16_dpp v58, v180, v83 row_newbcast:0 row_mask:0xf bank_mask:0xf
    v_dot2c_f32_bf16_dpp v59, v181, v83 row_newbcast:0 row_mask:0xf bank_mask:0xf
    v_dot2c_f32_bf16_dpp v52, v180, v84 row_newbcast:8 row_mask:0xf bank_mask:0xf
    v_dot2c_f32_bf16_dpp v53, v181, v84 row_newbcast:8 row_mask:0xf bank_mask:0xf
    v_dot2c_f32_bf16_dpp v54, v180, v85 row_newbcast:8 row_mask:0xf bank_mask:0xf
    v_dot2c_f32_bf16_dpp v55, v181, v85 row_newbcast:8 row_mask:0xf bank_mask:0xf
    v_dot2c_f32_bf16_dpp v56, v180, v86 row_newbcast:8 row_mask:0xf bank_mask:0xf
    v_dot2c_f32_bf16_dpp v57, v181, v86 row_newbcast:8 row_mask:0xf bank_mask:0xf
    v_dot2c_f32_bf16_dpp v58, v180, v87 row_newbcast:8 row_mask:0xf bank_mask:0xf
    v_dot2c_f32_bf16_dpp v59, v181, v87 row_newbcast:8 row_mask:0xf bank_mask:0xf
    v_dot2c_f32_bf16_dpp v52, v182, v88 row_newbcast:0 row_mask:0xf bank_mask:0xf
    v_dot2c_f32_bf16_dpp v53, v183, v88 row_newbcast:0 row_mask:0xf bank_mask:0xf
    v_dot2c_f32_bf16_dpp v54, v182, v89 row_newbcast:0 row_mask:0xf bank_mask:0xf
    v_dot2c_f32_bf16_dpp v55, v183, v89 row_newbcast:0 row_mask:0xf bank_mask:0xf
    v_dot2c_f32_bf16_dpp v56, v182, v90 row_newbcast:0 row_mask:0xf bank_mask:0xf
    v_dot2c_f32_bf16_dpp v57, v183, v90 row_newbcast:0 row_mask:0xf bank_mask:0xf
    v_dot2c_f32_bf16_dpp v58, v182, v91 row_newbcast:0 row_mask:0xf bank_mask:0xf
    v_dot2c_f32_bf16_dpp v59, v183, v91 row_newbcast:0 row_mask:0xf bank_mask:0xf
    v_dot2c_f32_bf16_dpp v52, v182, v92 row_newbcast:8 row_mask:0xf bank_mask:0xf
    v_dot2c_f32_bf16_dpp v53, v183, v92 row_newbcast:8 row_mask:0xf bank_mask:0xf
    v_dot2c_f32_bf16_dpp v54, v182, v93 row_newbcast:8 row_mask:0xf bank_mask:0xf
    v_dot2c_f32_bf16_dpp v55, v183, v93 row_newbcast:8 row_mask:0xf bank_mask:0xf
    v_dot2c_f32_bf16_dpp v56, v182, v94 row_newbcast:8 row_mask:0xf bank_mask:0xf
    v_dot2c_f32_bf16_dpp v57, v183, v94 row_newbcast:8 row_mask:0xf bank_mask:0xf
    v_dot2c_f32_bf16_dpp v58, v182, v95 row_newbcast:8 row_mask:0xf bank_mask:0xf
    v_dot2c_f32_bf16_dpp v59, v183, v95 row_newbcast:8 row_mask:0xf bank_mask:0xf
    s_add_u32 s54, s48, 344064
    s_waitcnt vmcnt(3)
    buffer_load_dwordx4 v[120:123], v16, s[20:23], s54 offen offset:0 nt
    s_waitcnt vmcnt(3)
    buffer_load_dwordx4 v[124:127], v16, s[20:23], s54 offen offset:1024 nt
    s_add_u32 s54, s48, 393216
    s_waitcnt vmcnt(3)
    buffer_load_dwordx4 v[128:131], v16, s[20:23], s54 offen offset:0 nt
    s_waitcnt vmcnt(3)
    buffer_load_dwordx4 v[132:135], v16, s[20:23], s54 offen offset:1024 nt
    v_dot2c_f32_bf16_dpp v52, v184, v96 row_newbcast:0 row_mask:0xf bank_mask:0xf
    v_dot2c_f32_bf16_dpp v53, v185, v96 row_newbcast:0 row_mask:0xf bank_mask:0xf
    v_dot2c_f32_bf16_dpp v54, v184, v97 row_newbcast:0 row_mask:0xf bank_mask:0xf
    v_dot2c_f32_bf16_dpp v55, v185, v97 row_newbcast:0 row_mask:0xf bank_mask:0xf
    v_dot2c_f32_bf16_dpp v56, v184, v98 row_newbcast:0 row_mask:0xf bank_mask:0xf
    v_dot2c_f32_bf16_dpp v57, v185, v98 row_newbcast:0 row_mask:0xf bank_mask:0xf
    v_dot2c_f32_bf16_dpp v58, v184, v99 row_newbcast:0 row_mask:0xf bank_mask:0xf
    v_dot2c_f32_bf16_dpp v59, v185, v99 row_newbcast:0 row_mask:0xf bank_mask:0xf
    v_dot2c_f32_bf16_dpp v52, v184, v100 row_newbcast:8 row_mask:0xf bank_mask:0xf
    v_dot2c_f32_bf16_dpp v53, v185, v100 row_newbcast:8 row_mask:0xf bank_mask:0xf
    v_dot2c_f32_bf16_dpp v54, v184, v101 row_newbcast:8 row_mask:0xf bank_mask:0xf
    v_dot2c_f32_bf16_dpp v55, v185, v101 row_newbcast:8 row_mask:0xf bank_mask:0xf
    v_dot2c_f32_bf16_dpp v56, v184, v102 row_newbcast:8 row_mask:0xf bank_mask:0xf
    v_dot2c_f32_bf16_dpp v57, v185, v102 row_newbcast:8 row_mask:0xf bank_mask:0xf
    v_dot2c_f32_bf16_dpp v58, v184, v103 row_newbcast:8 row_mask:0xf bank_mask:0xf
    v_dot2c_f32_bf16_dpp v59, v185, v103 row_newbcast:8 row_mask:0xf bank_mask:0xf
    v_dot2c_f32_bf16_dpp v52, v186, v104 row_newbcast:0 row_mask:0xf bank_mask:0xf
    v_dot2c_f32_bf16_dpp v53, v187, v104 row_newbcast:0 row_mask:0xf bank_mask:0xf
    v_dot2c_f32_bf16_dpp v54, v186, v105 row_newbcast:0 row_mask:0xf bank_mask:0xf
    v_dot2c_f32_bf16_dpp v55, v187, v105 row_newbcast:0 row_mask:0xf bank_mask:0xf
    v_dot2c_f32_bf16_dpp v56, v186, v106 row_newbcast:0 row_mask:0xf bank_mask:0xf
    v_dot2c_f32_bf16_dpp v57, v187, v106 row_newbcast:0 row_mask:0xf bank_mask:0xf
    v_dot2c_f32_bf16_dpp v58, v186, v107 row_newbcast:0 row_mask:0xf bank_mask:0xf
    v_dot2c_f32_bf16_dpp v59, v187, v107 row_newbcast:0 row_mask:0xf bank_mask:0xf
    v_dot2c_f32_bf16_dpp v52, v186, v108 row_newbcast:8 row_mask:0xf bank_mask:0xf
    v_dot2c_f32_bf16_dpp v53, v187, v108 row_newbcast:8 row_mask:0xf bank_mask:0xf
    v_dot2c_f32_bf16_dpp v54, v186, v109 row_newbcast:8 row_mask:0xf bank_mask:0xf
    v_dot2c_f32_bf16_dpp v55, v187, v109 row_newbcast:8 row_mask:0xf bank_mask:0xf
    v_dot2c_f32_bf16_dpp v56, v186, v110 row_newbcast:8 row_mask:0xf bank_mask:0xf
    v_dot2c_f32_bf16_dpp v57, v187, v110 row_newbcast:8 row_mask:0xf bank_mask:0xf
    v_dot2c_f32_bf16_dpp v58, v186, v111 row_newbcast:8 row_mask:0xf bank_mask:0xf
    v_dot2c_f32_bf16_dpp v59, v187, v111 row_newbcast:8 row_mask:0xf bank_mask:0xf
    v_dot2c_f32_bf16_dpp v52, v188, v112 row_newbcast:0 row_mask:0xf bank_mask:0xf
    v_dot2c_f32_bf16_dpp v53, v189, v112 row_newbcast:0 row_mask:0xf bank_mask:0xf
    v_dot2c_f32_bf16_dpp v54, v188, v113 row_newbcast:0 row_mask:0xf bank_mask:0xf
    v_dot2c_f32_bf16_dpp v55, v189, v113 row_newbcast:0 row_mask:0xf bank_mask:0xf
    v_dot2c_f32_bf16_dpp v56, v188, v114 row_newbcast:0 row_mask:0xf bank_mask:0xf
    v_dot2c_f32_bf16_dpp v57, v189, v114 row_newbcast:0 row_mask:0xf bank_mask:0xf
    v_dot2c_f32_bf16_dpp v58, v188, v115 row_newbcast:0 row_mask:0xf bank_mask:0xf
    v_dot2c_f32_bf16_dpp v59, v189, v115 row_newbcast:0 row_mask:0xf bank_mask:0xf
    v_dot2c_f32_bf16_dpp v52, v188, v116 row_newbcast:8 row_mask:0xf bank_mask:0xf
    v_dot2c_f32_bf16_dpp v53, v189, v116 row_newbcast:8 row_mask:0xf bank_mask:0xf
    v_dot2c_f32_bf16_dpp v54, v188, v117 row_newbcast:8 row_mask:0xf bank_mask:0xf
    v_dot2c_f32_bf16_dpp v55, v189, v117 row_newbcast:8 row_mask:0xf bank_mask:0xf
    v_dot2c_f32_bf16_dpp v56, v188, v118 row_newbcast:8 row_mask:0xf bank_mask:0xf
    v_dot2c_f32_bf16_dpp v57, v189, v118 row_newbcast:8 row_mask:0xf bank_mask:0xf
    v_dot2c_f32_bf16_dpp v58, v188, v119 row_newbcast:8 row_mask:0xf bank_mask:0xf
    v_dot2c_f32_bf16_dpp v59, v189, v119 row_newbcast:8 row_mask:0xf bank_mask:0xf
    s_add_u32 s54, s48, 442368
    s_waitcnt vmcnt(3)
    buffer_load_dwordx4 v[136:139], v16, s[20:23], s54 offen offset:0 nt
    s_waitcnt vmcnt(3)
    buffer_load_dwordx4 v[140:143], v16, s[20:23], s54 offen offset:1024 nt
    s_add_u32 s54, s48, 491520
    s_waitcnt vmcnt(3)
    buffer_load_dwordx4 v[144:147], v16, s[20:23], s54 offen offset:0 nt
    s_waitcnt vmcnt(3)
    buffer_load_dwordx4 v[148:151], v16, s[20:23], s54 offen offset:1024 nt
    v_dot2c_f32_bf16_dpp v52, v190, v120 row_newbcast:0 row_mask:0xf bank_mask:0xf
    v_dot2c_f32_bf16_dpp v53, v191, v120 row_newbcast:0 row_mask:0xf bank_mask:0xf
    v_dot2c_f32_bf16_dpp v54, v190, v121 row_newbcast:0 row_mask:0xf bank_mask:0xf
    v_dot2c_f32_bf16_dpp v55, v191, v121 row_newbcast:0 row_mask:0xf bank_mask:0xf
    v_dot2c_f32_bf16_dpp v56, v190, v122 row_newbcast:0 row_mask:0xf bank_mask:0xf
    v_dot2c_f32_bf16_dpp v57, v191, v122 row_newbcast:0 row_mask:0xf bank_mask:0xf
    v_dot2c_f32_bf16_dpp v58, v190, v123 row_newbcast:0 row_mask:0xf bank_mask:0xf
    v_dot2c_f32_bf16_dpp v59, v191, v123 row_newbcast:0 row_mask:0xf bank_mask:0xf
    v_dot2c_f32_bf16_dpp v52, v190, v124 row_newbcast:8 row_mask:0xf bank_mask:0xf
    v_dot2c_f32_bf16_dpp v53, v191, v124 row_newbcast:8 row_mask:0xf bank_mask:0xf
    v_dot2c_f32_bf16_dpp v54, v190, v125 row_newbcast:8 row_mask:0xf bank_mask:0xf
    v_dot2c_f32_bf16_dpp v55, v191, v125 row_newbcast:8 row_mask:0xf bank_mask:0xf
    v_dot2c_f32_bf16_dpp v56, v190, v126 row_newbcast:8 row_mask:0xf bank_mask:0xf
    v_dot2c_f32_bf16_dpp v57, v191, v126 row_newbcast:8 row_mask:0xf bank_mask:0xf
    v_dot2c_f32_bf16_dpp v58, v190, v127 row_newbcast:8 row_mask:0xf bank_mask:0xf
    v_dot2c_f32_bf16_dpp v59, v191, v127 row_newbcast:8 row_mask:0xf bank_mask:0xf
    v_dot2c_f32_bf16_dpp v52, v192, v128 row_newbcast:0 row_mask:0xf bank_mask:0xf
    v_dot2c_f32_bf16_dpp v53, v193, v128 row_newbcast:0 row_mask:0xf bank_mask:0xf
    v_dot2c_f32_bf16_dpp v54, v192, v129 row_newbcast:0 row_mask:0xf bank_mask:0xf
    v_dot2c_f32_bf16_dpp v55, v193, v129 row_newbcast:0 row_mask:0xf bank_mask:0xf
    v_dot2c_f32_bf16_dpp v56, v192, v130 row_newbcast:0 row_mask:0xf bank_mask:0xf
    v_dot2c_f32_bf16_dpp v57, v193, v130 row_newbcast:0 row_mask:0xf bank_mask:0xf
    v_dot2c_f32_bf16_dpp v58, v192, v131 row_newbcast:0 row_mask:0xf bank_mask:0xf
    v_dot2c_f32_bf16_dpp v59, v193, v131 row_newbcast:0 row_mask:0xf bank_mask:0xf
    v_dot2c_f32_bf16_dpp v52, v192, v132 row_newbcast:8 row_mask:0xf bank_mask:0xf
    v_dot2c_f32_bf16_dpp v53, v193, v132 row_newbcast:8 row_mask:0xf bank_mask:0xf
    v_dot2c_f32_bf16_dpp v54, v192, v133 row_newbcast:8 row_mask:0xf bank_mask:0xf
    v_dot2c_f32_bf16_dpp v55, v193, v133 row_newbcast:8 row_mask:0xf bank_mask:0xf
    v_dot2c_f32_bf16_dpp v56, v192, v134 row_newbcast:8 row_mask:0xf bank_mask:0xf
    v_dot2c_f32_bf16_dpp v57, v193, v134 row_newbcast:8 row_mask:0xf bank_mask:0xf
    v_dot2c_f32_bf16_dpp v58, v192, v135 row_newbcast:8 row_mask:0xf bank_mask:0xf
    v_dot2c_f32_bf16_dpp v59, v193, v135 row_newbcast:8 row_mask:0xf bank_mask:0xf
    s_waitcnt lgkmcnt(0)
    s_barrier
    ds_read_b128 v[8:11], v43
    ds_read_b128 v[12:15], v43 offset:16
    s_waitcnt lgkmcnt(0)
    v_max3_f32 v60, v8, v9, v10
    v_max3_f32 v12, v12, v13, v14
    v_max3_f32 v60, v60, v11, v15
    v_max_f32 v60, v60, v12
    v_sub_f32 v34, v31, v60
    v_exp_f32 v34, v34
    s_nop 0
    v_mul_f32 v61, v61, v34
    v_pk_mul_f32 v[52:53], v[52:53], v[34:35] op_sel_hi:[1,0]
    v_pk_mul_f32 v[54:55], v[54:55], v[34:35] op_sel_hi:[1,0]
    v_pk_mul_f32 v[56:57], v[56:57], v[34:35] op_sel_hi:[1,0]
    v_pk_mul_f32 v[58:59], v[58:59], v[34:35] op_sel_hi:[1,0]
    v_fma_f32 v169, v169, s52, -v60
    v_fma_f32 v170, v170, s52, -v60
    v_exp_f32 v169, v169
    v_exp_f32 v170, v170
    v_cvt_pk_bf16_f32 v194, v169, 0
    v_cvt_pk_bf16_f32 v195, 0, v169
    v_add_f32 v61, v61, v169
    v_cvt_pk_bf16_f32 v196, v170, 0
    v_cvt_pk_bf16_f32 v197, 0, v170
    v_add_f32 v61, v61, v170
    s_nop 1
    v_add_f32_dpp v61, v61, v61 row_ror:8 row_mask:0xf bank_mask:0xf
    v_mov_b32 v32, v61
    s_nop 1
    v_permlane16_swap_b32 v32, v61
    v_add_f32 v61, v61, v32
    v_mov_b32 v32, v61
    s_nop 1
    v_permlane32_swap_b32 v32, v61
    v_add_f32 v61, v61, v32
    ds_write_b32 v39, v61 offset:32
    s_cmp_lg_u32 s3, 3
    s_cselect_b64 vcc, -1, 0
    s_cbranch_scc1 L_pe_11
    s_add_u32 m0, s47, 0
    s_nop 0
    buffer_load_dwordx4 v17, s[24:27], s46 offen nt lds
    s_add_u32 s46, s46, 8192
    s_add_u32 m0, s47, 1024
    s_nop 0
    buffer_load_dwordx4 v18, s[24:27], s46 offen nt lds
    s_add_u32 s46, s46, 8192
    s_add_u32 m0, s47, 2048
    s_nop 0
    buffer_load_dwordx4 v17, s[24:27], s46 offen nt lds
    s_add_u32 s46, s46, 8192
    s_add_u32 m0, s47, 3072
    s_nop 0
    buffer_load_dwordx4 v18, s[24:27], s46 offen nt lds
    s_add_u32 s46, s46, 8192
L_pe_11:
    s_waitcnt vmcnt(7)
    s_cbranch_vccz L_lw_12
    s_waitcnt vmcnt(3)
L_lw_12:
    v_dot2c_f32_bf16_dpp v52, v194, v136 row_newbcast:0 row_mask:0xf bank_mask:0xf
    v_dot2c_f32_bf16_dpp v53, v195, v136 row_newbcast:0 row_mask:0xf bank_mask:0xf
    v_dot2c_f32_bf16_dpp v54, v194, v137 row_newbcast:0 row_mask:0xf bank_mask:0xf
    v_dot2c_f32_bf16_dpp v55, v195, v137 row_newbcast:0 row_mask:0xf bank_mask:0xf
    v_dot2c_f32_bf16_dpp v56, v194, v138 row_newbcast:0 row_mask:0xf bank_mask:0xf
    v_dot2c_f32_bf16_dpp v57, v195, v138 row_newbcast:0 row_mask:0xf bank_mask:0xf
    v_dot2c_f32_bf16_dpp v58, v194, v139 row_newbcast:0 row_mask:0xf bank_mask:0xf
    v_dot2c_f32_bf16_dpp v59, v195, v139 row_newbcast:0 row_mask:0xf bank_mask:0xf
    s_waitcnt vmcnt(6)
    s_cbranch_vccz L_lw_13
    s_waitcnt vmcnt(2)
L_lw_13:
    v_dot2c_f32_bf16_dpp v52, v194, v140 row_newbcast:8 row_mask:0xf bank_mask:0xf
    v_dot2c_f32_bf16_dpp v53, v195, v140 row_newbcast:8 row_mask:0xf bank_mask:0xf
    v_dot2c_f32_bf16_dpp v54, v194, v141 row_newbcast:8 row_mask:0xf bank_mask:0xf
    v_dot2c_f32_bf16_dpp v55, v195, v141 row_newbcast:8 row_mask:0xf bank_mask:0xf
    v_dot2c_f32_bf16_dpp v56, v194, v142 row_newbcast:8 row_mask:0xf bank_mask:0xf
    v_dot2c_f32_bf16_dpp v57, v195, v142 row_newbcast:8 row_mask:0xf bank_mask:0xf
    v_dot2c_f32_bf16_dpp v58, v194, v143 row_newbcast:8 row_mask:0xf bank_mask:0xf
    v_dot2c_f32_bf16_dpp v59, v195, v143 row_newbcast:8 row_mask:0xf bank_mask:0xf
    s_waitcnt vmcnt(5)
    s_cbranch_vccz L_lw_14
    s_waitcnt vmcnt(1)
L_lw_14:
    v_dot2c_f32_bf16_dpp v52, v196, v144 row_newbcast:0 row_mask:0xf bank_mask:0xf
    v_dot2c_f32_bf16_dpp v53, v197, v144 row_newbcast:0 row_mask:0xf bank_mask:0xf
    v_dot2c_f32_bf16_dpp v54, v196, v145 row_newbcast:0 row_mask:0xf bank_mask:0xf
    v_dot2c_f32_bf16_dpp v55, v197, v145 row_newbcast:0 row_mask:0xf bank_mask:0xf
    v_dot2c_f32_bf16_dpp v56, v196, v146 row_newbcast:0 row_mask:0xf bank_mask:0xf
    v_dot2c_f32_bf16_dpp v57, v197, v146 row_newbcast:0 row_mask:0xf bank_mask:0xf
    v_dot2c_f32_bf16_dpp v58, v196, v147 row_newbcast:0 row_mask:0xf bank_mask:0xf
    v_dot2c_f32_bf16_dpp v59, v197, v147 row_newbcast:0 row_mask:0xf bank_mask:0xf
    s_waitcnt vmcnt(4)
    s_cbranch_vccz L_lw_15
    s_waitcnt vmcnt(0)
L_lw_15:
    v_dot2c_f32_bf16_dpp v52, v196, v148 row_newbcast:8 row_mask:0xf bank_mask:0xf
    v_dot2c_f32_bf16_dpp v53, v197, v148 row_newbcast:8 row_mask:0xf bank_mask:0xf
    v_dot2c_f32_bf16_dpp v54, v196, v149 row_newbcast:8 row_mask:0xf bank_mask:0xf
    v_dot2c_f32_bf16_dpp v55, v197, v149 row_newbcast:8 row_mask:0xf bank_mask:0xf
    v_dot2c_f32_bf16_dpp v56, v196, v150 row_newbcast:8 row_mask:0xf bank_mask:0xf
    v_dot2c_f32_bf16_dpp v57, v197, v150 row_newbcast:8 row_mask:0xf bank_mask:0xf
    v_dot2c_f32_bf16_dpp v58, v196, v151 row_newbcast:8 row_mask:0xf bank_mask:0xf
    v_dot2c_f32_bf16_dpp v59, v197, v151 row_newbcast:8 row_mask:0xf bank_mask:0xf
L_afin:
    s_nop 2
    v_permlane32_swap_b32 v52, v56
    v_permlane32_swap_b32 v53, v57
    v_permlane32_swap_b32 v54, v58
    v_permlane32_swap_b32 v55, v59
    v_pk_add_f32 v[52:53], v[52:53], v[56:57]
    v_pk_add_f32 v[54:55], v[54:55], v[58:59]
    s_nop 1
    v_permlane16_swap_b32 v52, v54
    v_permlane16_swap_b32 v53, v55
    v_pk_add_f32 v[52:53], v[52:53], v[54:55]
    ds_write_b64 v38, v[52:53]
    s_waitcnt lgkmcnt(0)
    s_barrier
    s_cmp_lg_u32 s3, 3
    s_cbranch_scc1 L_amid
    ds_read_b128 v[208:211], v44
    ds_read_b128 v[212:215], v44 offset:512
    ds_read_b128 v[216:219], v44 offset:1024
    ds_read_b128 v[220:223], v44 offset:1536
    ds_read_b128 v[224:227], v43 offset:32
    ds_read_b128 v[228:231], v43 offset:48
    s_mov_b32 s38, 0xaaaaaaaa
    s_mov_b32 s39, s38
    v_mov_b32 v11, s32
    s_waitcnt lgkmcnt(4)
    v_pk_add_f32 v[208:209], v[208:209], v[212:213]
    v_pk_add_f32 v[210:211], v[210:211], v[214:215]
    s_waitcnt lgkmcnt(2)
    v_pk_add_f32 v[216:217], v[216:217], v[220:221]
    v_pk_add_f32 v[218:219], v[218:219], v[222:223]
    v_pk_add_f32 v[208:209], v[208:209], v[216:217]
    v_pk_add_f32 v[210:211], v[210:211], v[218:219]
    s_waitcnt lgkmcnt(0)
    v_pk_add_f32 v[224:225], v[224:225], v[226:227]
    v_permlane32_swap_b32 v208, v210
    v_permlane32_swap_b32 v209, v211
    v_pk_add_f32 v[228:229], v[228:229], v[230:231]
    v_pk_add_f32 v[208:209], v[208:209], v[210:211]
    v_pk_add_f32 v[224:225], v[224:225], v[228:229]
    v_cvt_pk_bf16_f32 v8, v208, v209
    v_cvt_pk_bf16_f32 v9, v208, v209
    v_add_f32 v61, v224, v225
    v_cndmask_b32 v10, v60, v61, s[38:39]
    v_permlane32_swap_b32 v8, v9
    s_mov_b32 exec_lo, 0xffffffff
    s_mov_b32 exec_hi, 0x0
    buffer_store_dwordx4 v[8:11], v16, s[12:15], s61 offen sc1
    ds_write_b64 v238, v[8:9]
    ds_write_b32 v239, v10
    s_mov_b64 exec, -1
    ds_write_b64 v246, v[240:241]
    ds_write_b32 v247, v242
    s_waitcnt vmcnt(1)
    s_branch L_e2bar
L_amid:
    s_add_u32 m0, s47, 0
    s_nop 0
    buffer_load_dwordx4 v17, s[24:27], s46 offen nt lds
    s_add_u32 s46, s46, 8192
    s_add_u32 m0, s47, 1024
    s_nop 0
    buffer_load_dwordx4 v18, s[24:27], s46 offen nt lds
    s_add_u32 s46, s46, 8192
    s_add_u32 m0, s47, 2048
    s_nop 0
    buffer_load_dwordx4 v17, s[24:27], s46 offen nt lds
    s_add_u32 s46, s46, 8192
    s_add_u32 m0, s47, 3072
    s_nop 0
    buffer_load_dwordx4 v18, s[24:27], s46 offen nt lds
    s_add_u32 s46, s46, 8192
    s_nop 0
L_stageE2:
    s_cmp_eq_u64 s[58:59], 0
    s_cbranch_scc1 L_nowr
    s_mov_b64 exec, s[58:59]
    s_bitcmp1_b32 0x37, s3
    s_cbranch_scc0 L_nopoll
    s_mov_b32 s37, 262144
L_h4:
    buffer_load_dwordx4 v[240:243], v245, s[12:15], s40 offen sc1
    s_sub_u32 s37, s37, 1
    s_waitcnt vmcnt(0)
    s_cbranch_scc1 L_nopoll
    v_cmp_ne_u32 vcc, s32, v243
    s_cbranch_vccnz L_h4
L_nopoll:
    ds_write_b64 v246, v[240:241]
    ds_write_b32 v247, v242
    s_mov_b64 exec, -1
L_nowr:
    s_waitcnt vmcnt(0)
L_e2bar:
    s_waitcnt lgkmcnt(0)
    s_barrier
    ds_read_b64 v[22:23], v249
    ds_read_b128 v[176:179], v248 offset:0
    ds_read_b64_tr_b16 v[160:161], v244 offset:0
    ds_read_b64_tr_b16 v[162:163], v244 offset:512
    ds_read_b128 v[180:183], v248 offset:64
    ds_read_b64_tr_b16 v[164:165], v244 offset:4096
    ds_read_b64_tr_b16 v[166:167], v244 offset:4608
    ds_read_b128 v[184:187], v248 offset:128
    ds_read_b64_tr_b16 v[168:169], v244 offset:8192
    ds_read_b64_tr_b16 v[170:171], v244 offset:8704
    ds_read_b128 v[188:191], v248 offset:192
    ds_read_b64_tr_b16 v[172:173], v244 offset:12288
    ds_read_b64_tr_b16 v[174:175], v244 offset:12800
    s_waitcnt lgkmcnt(12)
    v_max_f32_dpp v8, v22, v22 quad_perm:[1,0,3,2] row_mask:0xf bank_mask:0xf
    s_nop 1
    v_max_f32_dpp v8, v8, v8 quad_perm:[2,3,0,1] row_mask:0xf bank_mask:0xf
    v_sub_f32 v8, v22, v8
    v_exp_f32 v8, v8
    s_waitcnt lgkmcnt(9)
    v_mfma_f32_16x16x32_bf16 v[208:211], v[176:179], v[160:163], 0
    v_mul_f32 v9, v8, v23
    s_waitcnt lgkmcnt(6)
    v_mfma_f32_16x16x32_bf16 v[208:211], v[180:183], v[164:167], v[208:211]
    v_add_f32_dpp v9, v9, v9 quad_perm:[1,0,3,2] row_mask:0xf bank_mask:0xf
    s_waitcnt lgkmcnt(3)
    v_mfma_f32_16x16x32_bf16 v[208:211], v[184:187], v[168:171], v[208:211]
    v_add_f32_dpp v9, v9, v9 quad_perm:[2,3,0,1] row_mask:0xf bank_mask:0xf
    v_rcp_f32 v9, v9
    s_waitcnt lgkmcnt(0)
    v_mfma_f32_16x16x32_bf16 v[208:211], v[188:191], v[172:175], v[208:211]
    v_mul_f32 v8, v8, v9
    s_nop 1
    v_mov_b32_dpp v10, v8 row_newbcast:0 row_mask:0x1 bank_mask:0xf
    v_mov_b32_dpp v10, v8 row_newbcast:4 row_mask:0x2 bank_mask:0xf
    v_mov_b32_dpp v11, v8 row_newbcast:1 row_mask:0x1 bank_mask:0xf
    v_mov_b32_dpp v11, v8 row_newbcast:5 row_mask:0x2 bank_mask:0xf
    v_mov_b32_dpp v12, v8 row_newbcast:2 row_mask:0x1 bank_mask:0xf
    v_mov_b32_dpp v12, v8 row_newbcast:6 row_mask:0x2 bank_mask:0xf
    s_mov_b32 exec_lo, 0xffffffff
    s_mov_b32 exec_hi, 0x0
    v_mul_f32 v252, v10, v208
    v_fmac_f32 v252, v11, v209
    v_fmac_f32 v252, v12, v210
    v_bfi_b32 v252, v251, v253, v252
    buffer_store_dword v252, v250, s[12:15], s41 offen sc1
    s_mov_b64 exec, -1
    s_cmp_lg_u32 s3, 7
    s_cbranch_scc1 L_done
    s_and_b32 s33, s4, 5
    s_cbranch_scc1 L_done
    s_mov_b32 s37, 262144
L_fp:
    buffer_load_dwordx4 v[64:67], v16, s[12:15], s42 offen offset:0 sc1
    buffer_load_dwordx4 v[68:71], v16, s[12:15], s42 offen offset:1024 sc1
    buffer_load_dwordx4 v[72:75], v16, s[12:15], s42 offen offset:2048 sc1
    buffer_load_dwordx4 v[76:79], v16, s[12:15], s42 offen offset:3072 sc1
    s_sub_u32 s37, s37, 1
    s_waitcnt vmcnt(3)
    v_bitop3_b32 v10, v64, v65, s32 bitop3:0x7e
    v_bitop3_b32 v11, v66, v67, s32 bitop3:0x7e
    v_or_b32 v9, v10, v11
    s_waitcnt vmcnt(2)
    v_bitop3_b32 v10, v68, v69, s32 bitop3:0x7e
    v_bitop3_b32 v11, v70, v71, s32 bitop3:0x7e
    v_or3_b32 v9, v9, v10, v11
    s_waitcnt vmcnt(1)
    v_bitop3_b32 v10, v72, v73, s32 bitop3:0x7e
    v_bitop3_b32 v11, v74, v75, s32 bitop3:0x7e
    v_or3_b32 v9, v9, v10, v11
    s_waitcnt vmcnt(0)
    v_bitop3_b32 v10, v76, v77, s32 bitop3:0x7e
    v_bitop3_b32 v11, v78, v79, s32 bitop3:0x7e
    v_or3_b32 v9, v9, v10, v11
    v_and_b32 v9, 0xff, v9
    v_cmp_ne_u32 vcc, 0, v9
    s_cbranch_scc1 L_fok
    s_cbranch_vccnz L_fp
L_fok:
    v_and_b32 v64, 0xffffff00, v64
    v_and_b32 v65, 0xffffff00, v65
    v_and_b32 v66, 0xffffff00, v66
    v_and_b32 v67, 0xffffff00, v67
    v_and_b32 v68, 0xffffff00, v68
    v_and_b32 v69, 0xffffff00, v69
    v_and_b32 v70, 0xffffff00, v70
    v_and_b32 v71, 0xffffff00, v71
    v_and_b32 v72, 0xffffff00, v72
    v_and_b32 v73, 0xffffff00, v73
    v_and_b32 v74, 0xffffff00, v74
    v_and_b32 v75, 0xffffff00, v75
    v_and_b32 v76, 0xffffff00, v76
    v_and_b32 v77, 0xffffff00, v77
    v_and_b32 v78, 0xffffff00, v78
    v_and_b32 v79, 0xffffff00, v79
    v_pk_add_f32 v[64:65], v[64:65], v[68:69]
    v_pk_add_f32 v[72:73], v[72:73], v[76:77]
    v_pk_add_f32 v[66:67], v[66:67], v[70:71]
    v_pk_add_f32 v[74:75], v[74:75], v[78:79]
    v_pk_add_f32 v[64:65], v[64:65], v[72:73]
    v_pk_add_f32 v[66:67], v[66:67], v[74:75]
    s_nop 1
    v_permlane32_swap_b32 v64, v66
    v_permlane32_swap_b32 v65, v67
    v_pk_add_f32 v[64:65], v[64:65], v[66:67]
    s_nop 1
    v_permlane16_swap_b32 v64, v65
    v_add_f32 v64, v64, v65
    s_nop 1
    v_add_f32_dpp v8, v64, v64 row_ror:8 row_mask:0xf bank_mask:0xf
    v_add_f32_dpp v9, v64, v64 row_ror:8 row_mask:0xf bank_mask:0xf
    s_nop 1
    v_permlane16_swap_b32 v8, v9
    v_cvt_pk_bf16_f32 v10, v8, v9
    v_cvt_pk_bf16_f32 v11, v8, v9
    s_nop 1
    v_permlane32_swap_b32 v10, v11
    s_mov_b64 exec, 0xff
    buffer_store_dwordx2 v[10:11], v254, s[28:31], s43 offen sc1
L_done:
    s_endpgm
L_roleB:
    s_mov_b64 s[16:17], s[70:71]
    s_mov_b32 s18, 0x400000
    s_waitcnt vmcnt(3)
    buffer_load_dwordx4 v3, s[24:27], s43 offen nt lds
    s_add_u32 m0, s44, 73728
    s_add_u32 s43, s43, s41
    s_waitcnt vmcnt(3)
    buffer_load_dwordx4 v4, s[24:27], s43 offen nt lds
    s_add_u32 m0, s44, 98304
    s_add_u32 s43, s43, s41
    s_waitcnt lgkmcnt(0)
    s_add_u32 s32, s32, 1
    s_waitcnt vmcnt(3)
    buffer_load_dwordx4 v5, s[24:27], s43 offen nt lds
    s_add_u32 m0, s44, 106496
    s_add_u32 s43, s43, s41
    s_waitcnt vmcnt(3)
    buffer_load_dwordx4 v6, s[24:27], s43 offen nt lds
    s_add_u32 s43, s43, s41
    s_cmp_lt_u32 s3, 4
    s_cselect_b32 s33, 32, 80
    s_load_dwordx2 s[24:25], s[0:1], s33
    s_mov_b32 s26, 4194304
    s_waitcnt vmcnt(3)
    s_add_u32 m0, s44, 16384
    s_nop 0
    buffer_load_dwordx4 v3, s[8:11], s43 offen nt lds
    s_add_u32 s43, s43, s41
    s_waitcnt vmcnt(3)
    s_add_u32 m0, s44, 24576
    s_nop 0
    buffer_load_dwordx4 v4, s[8:11], s43 offen nt lds
    s_add_u32 s43, s43, s41
    s_waitcnt vmcnt(3)
    s_add_u32 m0, s44, 49152
    s_nop 0
    buffer_load_dwordx4 v3, s[8:11], s43 offen nt lds
    s_add_u32 s43, s43, s41
    s_waitcnt vmcnt(3)
    s_add_u32 m0, s44, 57344
    s_nop 0
    buffer_load_dwordx4 v4, s[8:11], s43 offen nt lds
    s_add_u32 s43, s43, s41
    s_waitcnt vmcnt(3)
    s_add_u32 m0, s44, 81920
    s_nop 0
    buffer_load_dwordx4 v3, s[8:11], s43 offen nt lds
    s_add_u32 s43, s43, s41
    s_waitcnt vmcnt(3)
    s_add_u32 m0, s44, 90112
    s_nop 0
    buffer_load_dwordx4 v4, s[8:11], s43 offen nt lds
    s_add_u32 s43, s43, s41
    s_waitcnt vmcnt(3)
    s_add_u32 m0, s44, 114688
    s_nop 0
    buffer_load_dwordx4 v3, s[8:11], s43 offen nt lds
    s_add_u32 s43, s43, s41
    s_waitcnt vmcnt(3)
    s_add_u32 m0, s44, 122880
    s_nop 0
    buffer_load_dwordx4 v4, s[8:11], s43 offen nt lds
    s_add_u32 s43, s43, s41
    s_and_b32 s54, s3, 3
    s_lshr_b32 s55, s3, 2
    v_and_b32 v7, 3, v1
    v_lshlrev_b32 v7, 2, v7
    v_lshrrev_b32 v8, 2, v1
    v_or_b32 v7, v7, v8
    v_lshlrev_b32 v7, 4, v7
    v_lshl_add_u32 v7, v2, 8, v7
    v_lshl_add_u32 v7, v1, 10, v7
    s_lshl_b32 s33, s54, 15
    v_add_u32 v28, s33, v7
    v_lshlrev_b32 v7, 4, v1
    v_lshl_add_u32 v7, v2, 8, v7
    v_lshl_add_u32 v7, v1, 10, v7
    s_lshl_b32 s33, s55, 14
    s_add_u32 s33, s33, 131072
    v_add_u32 v29, s33, v7
    v_lshrrev_b32 v9, 1, v2
    v_and_b32 v10, 1, v2
    v_bfe_u32 v11, v0, 1, 1
    v_lshl_or_b32 v11, v10, 1, v11
    s_lshl_b32 s33, s3, 3
    v_or_b32 v11, s33, v11
    v_lshlrev_b32 v12, 2, v8
    v_lshl_or_b32 v12, v9, 1, v12
    v_xor_b32 v11, v11, v12
    v_lshlrev_b32 v11, 4, v11
    v_lshl_add_u32 v12, v9, 3, v8
    v_lshl_add_u32 v11, v12, 10, v11
    v_and_b32 v12, 1, v0
    v_lshl_add_u32 v20, v12, 3, v11
    v_xor_b32 v21, 16, v20
    v_add_u32 v21, 4096, v21
    v_xor_b32 v22, 64, v20
    v_xor_b32 v23, 64, v21
    v_add_u32 v24, 65536, v20
    v_add_u32 v25, 65536, v21
    v_add_u32 v26, 65536, v22
    v_add_u32 v27, 65536, v23
    s_lshl_b32 s33, s55, 8
    s_add_u32 s33, s33, 140288
    v_lshl_add_u32 v30, v1, 4, s33
    s_lshl_b32 s33, s54, 2
    v_add_u32 v31, s33, v30
    v_and_b32 v7, 31, v0
    v_lshlrev_b32 v56, 4, v7
    v_add_u32 v56, 140288, v56
    v_mul_u32_u24 v60, 272, v7
    v_lshl_add_u32 v60, v9, 4, v60
    v_add_u32 v60, 141312, v60
    v_mul_u32_u24 v61, 272, v1
    v_lshl_add_u32 v61, v2, 3, v61
    s_mul_i32 s33, s55, 4352
    s_lshl_b32 s36, s54, 6
    s_add_u32 s33, s33, s36
    s_add_u32 s33, s33, 141312
    v_add_u32 v61, s33, v61
    v_add_u32 v19, s44, v16
    v_add_u32 v62, 65536, v19
    v_mov_b32 v57, 0xff7fffff
    v_mov_b32 v58, 0xff7fffff
    v_mov_b32 v59, 0
    v_lshlrev_b32 v7, 1, v2
    v_xor_b32 v7, v7, v1
    v_lshlrev_b32 v7, 4, v7
    v_lshl_add_u32 v5, v2, 13, v7
    v_xor_b32 v6, 128, v5
    s_lshl_b32 s45, s6, 21
    s_lshl_b32 s36, s3, 18
    s_add_u32 s45, s45, s36
    s_lshl_b32 s36, s4, 8
    s_add_u32 s45, s45, s36
    v_mov_b32 v160, 0
    v_mov_b32 v161, 0
    v_mov_b32 v162, 0
    v_mov_b32 v163, 0
    v_mov_b32 v164, 0
    v_mov_b32 v165, 0
    v_mov_b32 v166, 0
    v_mov_b32 v167, 0
    v_mov_b32 v168, 0
    v_mov_b32 v169, 0
    v_mov_b32 v170, 0
    v_mov_b32 v171, 0
    v_mov_b32 v172, 0
    v_mov_b32 v173, 0
    v_mov_b32 v174, 0
    v_mov_b32 v175, 0
    v_mov_b32 v176, 0
    v_mov_b32 v177, 0
    v_mov_b32 v178, 0
    v_mov_b32 v179, 0
    v_mov_b32 v180, 0
    v_mov_b32 v181, 0
    v_mov_b32 v182, 0
    v_mov_b32 v183, 0
    v_mov_b32 v184, 0
    v_mov_b32 v185, 0
    v_mov_b32 v186, 0
    v_mov_b32 v187, 0
    v_mov_b32 v188, 0
    v_mov_b32 v189, 0
    v_mov_b32 v190, 0
    v_mov_b32 v191, 0
    s_lshl_b32 s33, s4, 1
    s_add_u32 s33, s33, s6
    s_and_b32 s33, s33, 15
    s_lshl_b32 s33, s33, 3
    s_add_u32 s33, s33, s3
    s_lshl_b32 s33, s33, 7
    s_add_u32 s33, s33, 262144
    s_add_u32 s34, s12, s33
    s_addc_u32 s35, s13, 0
    s_lshl_b32 s49, s6, 15
    s_lshl_b32 s36, s3, 12
    s_add_u32 s49, s49, s36
    s_add_u32 s49, s49, 196608
    s_add_u32 s50, s36, 131072
    s_mov_b32 s60, s32
    s_mov_b32 s61, s32
    s_waitcnt vmcnt(3)
    s_add_u32 s33, s43, 122880
    buffer_load_dwordx4 v[220:223], v4, s[8:11], s33 offen nt
    s_waitcnt vmcnt(3)
    s_add_u32 s33, s43, 114688
    buffer_load_dwordx4 v[216:219], v3, s[8:11], s33 offen nt
    s_load_dwordx8 s[64:71], s[34:35], 0 glc
    s_waitcnt vmcnt(3)
    s_add_u32 s33, s43, 106496
    buffer_load_dwordx4 v[212:215], v4, s[8:11], s33 offen nt
    s_waitcnt vmcnt(3)
    s_add_u32 s33, s43, 98304
    buffer_load_dwordx4 v[208:211], v3, s[8:11], s33 offen nt
    s_mov_b32 s62, 12
    s_waitcnt lgkmcnt(0)
    s_xor_b64 s[64:65], s[64:65], s[60:61]
    s_xor_b64 s[66:67], s[66:67], s[60:61]
    s_xor_b64 s[68:69], s[68:69], s[60:61]
    s_xor_b64 s[70:71], s[70:71], s[60:61]
    s_or_b64 s[64:65], s[64:65], s[66:67]
    s_or_b64 s[68:69], s[68:69], s[70:71]
    s_or_b64 s[64:65], s[64:65], s[68:69]
    s_cbranch_scc0 L_h2ok
    s_load_dwordx8 s[64:71], s[34:35], 0 glc
    s_waitcnt vmcnt(3)
    s_add_u32 s33, s43, 90112
    buffer_load_dwordx4 v[252:255], v4, s[8:11], s33 offen nt
    s_waitcnt vmcnt(3)
    s_add_u32 s33, s43, 81920
    buffer_load_dwordx4 v[248:251], v3, s[8:11], s33 offen nt
    s_mov_b32 s62, 10
    s_waitcnt lgkmcnt(0)
    s_xor_b64 s[64:65], s[64:65], s[60:61]
    s_xor_b64 s[66:67], s[66:67], s[60:61]
    s_xor_b64 s[68:69], s[68:69], s[60:61]
    s_xor_b64 s[70:71], s[70:71], s[60:61]
    s_or_b64 s[64:65], s[64:65], s[66:67]
    s_or_b64 s[68:69], s[68:69], s[70:71]
    s_or_b64 s[64:65], s[64:65], s[68:69]
    s_cbranch_scc0 L_h2ok
    s_load_dwordx8 s[64:71], s[34:35], 0 glc
    s_waitcnt vmcnt(3)
    s_add_u32 s33, s43, 73728
    buffer_load_dwordx4 v[244:247], v4, s[8:11], s33 offen nt
    s_waitcnt vmcnt(3)
    s_add_u32 s33, s43, 65536
    buffer_load_dwordx4 v[240:243], v3, s[8:11], s33 offen nt
    s_mov_b32 s62, 8
    s_waitcnt lgkmcnt(0)
    s_xor_b64 s[64:65], s[64:65], s[60:61]
    s_xor_b64 s[66:67], s[66:67], s[60:61]
    s_xor_b64 s[68:69], s[68:69], s[60:61]
    s_xor_b64 s[70:71], s[70:71], s[60:61]
    s_or_b64 s[64:65], s[64:65], s[66:67]
    s_or_b64 s[68:69], s[68:69], s[70:71]
    s_or_b64 s[64:65], s[64:65], s[68:69]
    s_cbranch_scc0 L_h2ok
    s_load_dwordx8 s[64:71], s[34:35], 0 glc
    s_waitcnt vmcnt(3)
    s_add_u32 s33, s43, 57344
    buffer_load_dwordx4 v[236:239], v4, s[8:11], s33 offen nt
    s_waitcnt vmcnt(3)
    s_add_u32 s33, s43, 49152
    buffer_load_dwordx4 v[232:235], v3, s[8:11], s33 offen nt
    s_mov_b32 s62, 6
    s_waitcnt lgkmcnt(0)
    s_xor_b64 s[64:65], s[64:65], s[60:61]
    s_xor_b64 s[66:67], s[66:67], s[60:61]
    s_xor_b64 s[68:69], s[68:69], s[60:61]
    s_xor_b64 s[70:71], s[70:71], s[60:61]
    s_or_b64 s[64:65], s[64:65], s[66:67]
    s_or_b64 s[68:69], s[68:69], s[70:71]
    s_or_b64 s[64:65], s[64:65], s[68:69]
    s_cbranch_scc0 L_h2ok
    s_load_dwordx8 s[64:71], s[34:35], 0 glc
    s_waitcnt vmcnt(3)
    s_add_u32 s33, s43, 40960
    buffer_load_dwordx4 v[228:231], v4, s[8:11], s33 offen nt
    s_waitcnt vmcnt(3)
    s_add_u32 s33, s43, 32768
    buffer_load_dwordx4 v[224:227], v3, s[8:11], s33 offen nt
    s_mov_b32 s62, 4
    s_waitcnt lgkmcnt(0)
    s_xor_b64 s[64:65], s[64:65], s[60:61]
    s_xor_b64 s[66:67], s[66:67], s[60:61]
    s_xor_b64 s[68:69], s[68:69], s[60:61]
    s_xor_b64 s[70:71], s[70:71], s[60:61]
    s_or_b64 s[64:65], s[64:65], s[66:67]
    s_or_b64 s[68:69], s[68:69], s[70:71]
    s_or_b64 s[64:65], s[64:65], s[68:69]
    s_cbranch_scc0 L_h2ok
    s_mov_b32 s62, 4
    s_mov_b32 s37, 262144
L_h2:
    s_load_dwordx8 s[64:71], s[34:35], 0 glc
    s_sub_u32 s37, s37, 1
    s_waitcnt lgkmcnt(0)
    s_cbranch_scc1 L_h2ok
    s_xor_b64 s[64:65], s[64:65], s[60:61]
    s_xor_b64 s[66:67], s[66:67], s[60:61]
    s_xor_b64 s[68:69], s[68:69], s[60:61]
    s_xor_b64 s[70:71], s[70:71], s[60:61]
    s_or_b64 s[64:65], s[64:65], s[66:67]
    s_or_b64 s[68:69], s[68:69], s[70:71]
    s_or_b64 s[64:65], s[64:65], s[68:69]
    s_cbranch_scc1 L_h2
L_h2ok:
    s_lshl_b32 s33, s54, 6
    v_xor_b32 v12, s33, v16
    v_xor_b32 v13, 16, v12
    v_xor_b32 v14, 32, v12
    v_xor_b32 v15, 48, v12
    s_mov_b32 m0, s50
    s_nop 0
    buffer_load_dwordx4 v12, s[12:15], s49 offen offset:0 sc1 lds
    buffer_load_dwordx4 v13, s[12:15], s49 offen offset:1024 sc1 lds
    buffer_load_dwordx4 v14, s[12:15], s49 offen offset:2048 sc1 lds
    buffer_load_dwordx4 v15, s[12:15], s49 offen offset:3072 sc1 lds
    s_barrier
    s_waitcnt vmcnt(5)
    s_add_u32 s33, s43, 0
    buffer_load_dwordx4 v[192:195], v3, s[8:11], s33 offen nt
    s_waitcnt vmcnt(5)
    s_add_u32 s33, s43, 8192
    buffer_load_dwordx4 v[196:199], v4, s[8:11], s33 offen nt
    s_waitcnt vmcnt(5)
    s_add_u32 s33, s43, 16384
    buffer_load_dwordx4 v[200:203], v3, s[8:11], s33 offen nt
    s_waitcnt vmcnt(5)
    s_add_u32 s33, s43, 24576
    buffer_load_dwordx4 v[204:207], v4, s[8:11], s33 offen nt
    s_waitcnt vmcnt(4)
    s_barrier
    s_mov_b32 s37, 4096
L_qa:
    v_xor_b32 v7, 0, v29
    ds_read_b128 v[64:67], v7
    v_xor_b32 v7, 16, v29
    ds_read_b128 v[68:71], v7
    v_xor_b32 v7, 32, v29
    ds_read_b128 v[72:75], v7
    v_xor_b32 v7, 48, v29
    ds_read_b128 v[76:79], v7
    v_xor_b32 v7, 64, v29
    ds_read_b128 v[80:83], v7
    v_xor_b32 v7, 80, v29
    ds_read_b128 v[84:87], v7
    v_xor_b32 v7, 96, v29
    ds_read_b128 v[88:91], v7
    v_xor_b32 v7, 112, v29
    ds_read_b128 v[92:95], v7
    v_xor_b32 v7, 128, v29
    ds_read_b128 v[96:99], v7
    v_xor_b32 v7, 144, v29
    ds_read_b128 v[100:103], v7
    v_xor_b32 v7, 160, v29
    ds_read_b128 v[104:107], v7
    v_xor_b32 v7, 176, v29
    ds_read_b128 v[108:111], v7
    v_xor_b32 v7, 192, v29
    ds_read_b128 v[112:115], v7
    v_xor_b32 v7, 208, v29
    ds_read_b128 v[116:119], v7
    v_xor_b32 v7, 224, v29
    ds_read_b128 v[120:123], v7
    v_xor_b32 v7, 240, v29
    ds_read_b128 v[124:127], v7
    s_waitcnt lgkmcnt(0)
    s_barrier
    v_xor_b32 v7, 0, v28
    ds_read_b128 v[128:131], v7 offset:0
    ds_read_b128 v[132:135], v7 offset:16384
    v_xor_b32 v7, 16, v28
    ds_read_b128 v[136:139], v7 offset:0
    ds_read_b128 v[140:143], v7 offset:16384
    v_xor_b32 v7, 32, v28
    ds_read_b128 v[144:147], v7 offset:0
    ds_read_b128 v[148:151], v7 offset:16384
    v_xor_b32 v7, 48, v28
    ds_read_b128 v[152:155], v7 offset:0
    ds_read_b128 v[156:159], v7 offset:16384
    s_waitcnt lgkmcnt(7)
    v_mfma_f32_16x16x32_bf16 v[48:51], v[128:131], v[64:67], 0
    s_cmp_le_u32 s62, 4
    s_cbranch_scc1 L_lt_16
    s_add_u32 s33, s43, 32768
    buffer_load_dwordx4 v[224:227], v3, s[8:11], s33 offen nt
L_lt_16:
    v_xor_b32 v7, 64, v28
    ds_read_b128 v[128:131], v7 offset:0
    s_waitcnt lgkmcnt(7)
    v_mfma_f32_16x16x32_bf16 v[52:55], v[132:135], v[64:67], 0
    ds_read_b128 v[132:135], v7 offset:16384
    s_waitcnt lgkmcnt(7)
    v_mfma_f32_16x16x32_bf16 v[48:51], v[136:139], v[68:71], v[48:51]
    v_xor_b32 v7, 80, v28
    ds_read_b128 v[136:139], v7 offset:0
    s_waitcnt lgkmcnt(7)
    v_mfma_f32_16x16x32_bf16 v[52:55], v[140:143], v[68:71], v[52:55]
    ds_read_b128 v[140:143], v7 offset:16384
    s_waitcnt lgkmcnt(7)
    v_mfma_f32_16x16x32_bf16 v[48:51], v[144:147], v[72:75], v[48:51]
    v_xor_b32 v7, 96, v28
    ds_read_b128 v[144:147], v7 offset:0
    s_waitcnt lgkmcnt(7)
    v_mfma_f32_16x16x32_bf16 v[52:55], v[148:151], v[72:75], v[52:55]
    ds_read_b128 v[148:151], v7 offset:16384
    s_waitcnt lgkmcnt(7)
    v_mfma_f32_16x16x32_bf16 v[48:51], v[152:155], v[76:79], v[48:51]
    v_xor_b32 v7, 112, v28
    ds_read_b128 v[152:155], v7 offset:0
    s_waitcnt lgkmcnt(7)
    v_mfma_f32_16x16x32_bf16 v[52:55], v[156:159], v[76:79], v[52:55]
    ds_read_b128 v[156:159], v7 offset:16384
    s_waitcnt lgkmcnt(7)
    v_mfma_f32_16x16x32_bf16 v[48:51], v[128:131], v[80:83], v[48:51]
    v_xor_b32 v7, 128, v28
    ds_read_b128 v[128:131], v7 offset:0
    s_waitcnt lgkmcnt(7)
    v_mfma_f32_16x16x32_bf16 v[52:55], v[132:135], v[80:83], v[52:55]
    s_cmp_le_u32 s62, 5
    s_cbranch_scc1 L_lt_17
    s_add_u32 s33, s43, 40960
    buffer_load_dwordx4 v[228:231], v4, s[8:11], s33 offen nt
L_lt_17:
    ds_read_b128 v[132:135], v7 offset:16384
    s_waitcnt lgkmcnt(7)
    v_mfma_f32_16x16x32_bf16 v[48:51], v[136:139], v[84:87], v[48:51]
    v_xor_b32 v7, 144, v28
    ds_read_b128 v[136:139], v7 offset:0
    s_waitcnt lgkmcnt(7)
    v_mfma_f32_16x16x32_bf16 v[52:55], v[140:143], v[84:87], v[52:55]
    ds_read_b128 v[140:143], v7 offset:16384
    s_waitcnt lgkmcnt(7)
    v_mfma_f32_16x16x32_bf16 v[48:51], v[144:147], v[88:91], v[48:51]
    v_xor_b32 v7, 160, v28
    ds_read_b128 v[144:147], v7 offset:0
    s_waitcnt lgkmcnt(7)
    v_mfma_f32_16x16x32_bf16 v[52:55], v[148:151], v[88:91], v[52:55]
    ds_read_b128 v[148:151], v7 offset:16384
    s_waitcnt lgkmcnt(7)
    v_mfma_f32_16x16x32_bf16 v[48:51], v[152:155], v[92:95], v[48:51]
    v_xor_b32 v7, 176, v28
    ds_read_b128 v[152:155], v7 offset:0
    s_waitcnt lgkmcnt(7)
    v_mfma_f32_16x16x32_bf16 v[52:55], v[156:159], v[92:95], v[52:55]
    ds_read_b128 v[156:159], v7 offset:16384
    s_waitcnt lgkmcnt(7)
    v_mfma_f32_16x16x32_bf16 v[48:51], v[128:131], v[96:99], v[48:51]
    v_xor_b32 v7, 192, v28
    ds_read_b128 v[128:131], v7 offset:0
    s_waitcnt lgkmcnt(7)
    v_mfma_f32_16x16x32_bf16 v[52:55], v[132:135], v[96:99], v[52:55]
    ds_read_b128 v[132:135], v7 offset:16384
    s_waitcnt lgkmcnt(7)
    v_mfma_f32_16x16x32_bf16 v[48:51], v[136:139], v[100:103], v[48:51]
    s_cmp_le_u32 s62, 6
    s_cbranch_scc1 L_lt_18
    s_add_u32 s33, s43, 49152
    buffer_load_dwordx4 v[232:235], v3, s[8:11], s33 offen nt
L_lt_18:
    v_xor_b32 v7, 208, v28
    ds_read_b128 v[136:139], v7 offset:0
    s_waitcnt lgkmcnt(7)
    v_mfma_f32_16x16x32_bf16 v[52:55], v[140:143], v[100:103], v[52:55]
    ds_read_b128 v[140:143], v7 offset:16384
    s_waitcnt lgkmcnt(7)
    v_mfma_f32_16x16x32_bf16 v[48:51], v[144:147], v[104:107], v[48:51]
    v_xor_b32 v7, 224, v28
    ds_read_b128 v[144:147], v7 offset:0
    s_waitcnt lgkmcnt(7)
    v_mfma_f32_16x16x32_bf16 v[52:55], v[148:151], v[104:107], v[52:55]
    ds_read_b128 v[148:151], v7 offset:16384
    s_waitcnt lgkmcnt(7)
    v_mfma_f32_16x16x32_bf16 v[48:51], v[152:155], v[108:111], v[48:51]
    v_xor_b32 v7, 240, v28
    ds_read_b128 v[152:155], v7 offset:0
    s_waitcnt lgkmcnt(7)
    v_mfma_f32_16x16x32_bf16 v[52:55], v[156:159], v[108:111], v[52:55]
    ds_read_b128 v[156:159], v7 offset:16384
    s_waitcnt lgkmcnt(7)
    v_mfma_f32_16x16x32_bf16 v[48:51], v[128:131], v[112:115], v[48:51]
    s_waitcnt lgkmcnt(6)
    v_mfma_f32_16x16x32_bf16 v[52:55], v[132:135], v[112:115], v[52:55]
    s_waitcnt lgkmcnt(5)
    v_mfma_f32_16x16x32_bf16 v[48:51], v[136:139], v[116:119], v[48:51]
    s_waitcnt lgkmcnt(4)
    v_mfma_f32_16x16x32_bf16 v[52:55], v[140:143], v[116:119], v[52:55]
    s_cmp_le_u32 s62, 7
    s_cbranch_scc1 L_lt_19
    s_add_u32 s33, s43, 57344
    buffer_load_dwordx4 v[236:239], v4, s[8:11], s33 offen nt
L_lt_19:
    s_waitcnt lgkmcnt(3)
    v_mfma_f32_16x16x32_bf16 v[48:51], v[144:147], v[120:123], v[48:51]
    s_waitcnt lgkmcnt(2)
    v_mfma_f32_16x16x32_bf16 v[52:55], v[148:151], v[120:123], v[52:55]
    s_waitcnt lgkmcnt(1)
    v_mfma_f32_16x16x32_bf16 v[48:51], v[152:155], v[124:127], v[48:51]
    s_waitcnt lgkmcnt(0)
    v_mfma_f32_16x16x32_bf16 v[52:55], v[156:159], v[124:127], v[52:55]
    s_nop 5
    v_max3_f32 v7, v48, v49, v50
    s_nop 0
    v_max3_f32 v8, v52, v53, v54
    v_max3_f32 v7, v7, v51, v55
    v_max_f32 v7, v7, v8
    v_mov_b32 v8, v7
    s_nop 1
    v_permlane16_swap_b32 v8, v7
    v_max_f32 v7, v7, v8
    v_mov_b32 v8, v7
    s_nop 1
    v_permlane32_swap_b32 v8, v7
    v_max_f32 v7, v7, v8
    v_mul_f32 v7, s52, v7
    ds_write_b32 v31, v7
    ds_read_b64_tr_b16 v[128:129], v20 offset:0
    ds_read_b64_tr_b16 v[130:131], v21 offset:0
    ds_read_b64_tr_b16 v[132:133], v22 offset:0
    ds_read_b64_tr_b16 v[134:135], v23 offset:0
    ds_read_b64_tr_b16 v[136:137], v20 offset:16384
    ds_read_b64_tr_b16 v[138:139], v21 offset:16384
    ds_read_b64_tr_b16 v[140:141], v22 offset:16384
    ds_read_b64_tr_b16 v[142:143], v23 offset:16384
    ds_read_b64_tr_b16 v[144:145], v20 offset:32768
    ds_read_b64_tr_b16 v[146:147], v21 offset:32768
    ds_read_b64_tr_b16 v[148:149], v22 offset:32768
    ds_read_b64_tr_b16 v[150:151], v23 offset:32768
    s_waitcnt lgkmcnt(12)
    s_barrier
    ds_read_b128 v[8:11], v30
    ds_read_b128 v[12:15], v56
    s_waitcnt lgkmcnt(0)
    ds_read_b64_tr_b16 v[152:153], v20 offset:49152
    ds_read_b64_tr_b16 v[154:155], v21 offset:49152
    ds_read_b64_tr_b16 v[156:157], v22 offset:49152
    ds_read_b64_tr_b16 v[158:159], v23 offset:49152
    v_max3_f32 v8, v8, v9, v10
    v_max3_f32 v8, v8, v11, v57
    v_fma_f32 v48, v48, s52, -v8
    v_fma_f32 v49, v49, s52, -v8
    v_fma_f32 v50, v50, s52, -v8
    v_fma_f32 v51, v51, s52, -v8
    v_fma_f32 v52, v52, s52, -v8
    v_fma_f32 v53, v53, s52, -v8
    v_fma_f32 v54, v54, s52, -v8
    v_fma_f32 v55, v55, s52, -v8
    v_exp_f32 v48, v48
    v_exp_f32 v49, v49
    v_exp_f32 v50, v50
    v_exp_f32 v51, v51
    v_exp_f32 v52, v52
    v_exp_f32 v53, v53
    v_exp_f32 v54, v54
    v_exp_f32 v55, v55
    v_max3_f32 v12, v12, v13, v14
    v_cvt_pk_bf16_f32 v32, v48, v49
    v_cvt_pk_bf16_f32 v33, v50, v51
    v_cvt_pk_bf16_f32 v34, v52, v53
    v_cvt_pk_bf16_f32 v35, v54, v55
    ds_write_b64 v61, v[32:33] offset:0
    ds_write_b64 v61, v[34:35] offset:32
    v_sub_f32 v9, v57, v8
    v_max3_f32 v12, v12, v15, v58
    v_exp_f32 v9, v9
    v_sub_f32 v14, v58, v12
    v_mov_b32 v57, v8
    v_exp_f32 v14, v14
    v_mov_b32 v58, v12
    v_pk_add_f32 v[48:49], v[48:49], v[50:51]
    v_pk_add_f32 v[52:53], v[52:53], v[54:55]
    v_pk_add_f32 v[48:49], v[48:49], v[52:53]
    v_fma_f32 v59, v59, v9, v48
    v_add_f32 v59, v59, v49
    s_waitcnt lgkmcnt(0)
    s_barrier
    ds_read_b128 v[32:35], v60 offset:0
    ds_read_b128 v[36:39], v60 offset:32
    ds_read_b128 v[40:43], v60 offset:64
    ds_read_b128 v[44:47], v60 offset:96
    s_waitcnt lgkmcnt(0)
    v_mfma_f32_32x32x16_bf16 v[160:175], v[128:131], v[32:35], v[160:175]
    v_mfma_f32_32x32x16_bf16 v[176:191], v[132:135], v[32:35], v[176:191]
    s_cmp_le_u32 s62, 8
    s_cbranch_scc1 L_lt_20
    s_add_u32 s33, s43, 65536
    buffer_load_dwordx4 v[240:243], v3, s[8:11], s33 offen nt
L_lt_20:
    ds_read_b128 v[32:35], v60 offset:128
    ds_read_b64_tr_b16 v[128:129], v24 offset:0
    ds_read_b64_tr_b16 v[130:131], v25 offset:0
    ds_read_b64_tr_b16 v[132:133], v26 offset:0
    ds_read_b64_tr_b16 v[134:135], v27 offset:0
    v_mfma_f32_32x32x16_bf16 v[160:175], v[136:139], v[36:39], v[160:175]
    v_mfma_f32_32x32x16_bf16 v[176:191], v[140:143], v[36:39], v[176:191]
    ds_read_b128 v[36:39], v60 offset:160
    ds_read_b64_tr_b16 v[136:137], v24 offset:16384
    ds_read_b64_tr_b16 v[138:139], v25 offset:16384
    ds_read_b64_tr_b16 v[140:141], v26 offset:16384
    ds_read_b64_tr_b16 v[142:143], v27 offset:16384
    v_mfma_f32_32x32x16_bf16 v[160:175], v[144:147], v[40:43], v[160:175]
    v_mfma_f32_32x32x16_bf16 v[176:191], v[148:151], v[40:43], v[176:191]
    s_cmp_le_u32 s62, 9
    s_cbranch_scc1 L_lt_21
    s_add_u32 s33, s43, 73728
    buffer_load_dwordx4 v[244:247], v4, s[8:11], s33 offen nt
L_lt_21:
    ds_read_b128 v[40:43], v60 offset:192
    ds_read_b64_tr_b16 v[144:145], v24 offset:32768
    ds_read_b64_tr_b16 v[146:147], v25 offset:32768
    ds_read_b64_tr_b16 v[148:149], v26 offset:32768
    ds_read_b64_tr_b16 v[150:151], v27 offset:32768
    v_mfma_f32_32x32x16_bf16 v[160:175], v[152:155], v[44:47], v[160:175]
    v_mfma_f32_32x32x16_bf16 v[176:191], v[156:159], v[44:47], v[176:191]
    s_waitcnt lgkmcnt(10)
    ds_read_b128 v[44:47], v60 offset:224
    ds_read_b64_tr_b16 v[152:153], v24 offset:49152
    ds_read_b64_tr_b16 v[154:155], v25 offset:49152
    ds_read_b64_tr_b16 v[156:157], v26 offset:49152
    ds_read_b64_tr_b16 v[158:159], v27 offset:49152
    v_mfma_f32_32x32x16_bf16 v[160:175], v[128:131], v[32:35], v[160:175]
    v_mfma_f32_32x32x16_bf16 v[176:191], v[132:135], v[32:35], v[176:191]
    s_cmp_le_u32 s62, 10
    s_cbranch_scc1 L_lt_22
    s_add_u32 s33, s43, 81920
    buffer_load_dwordx4 v[248:251], v3, s[8:11], s33 offen nt
L_lt_22:
    s_waitcnt lgkmcnt(10)
    v_mfma_f32_32x32x16_bf16 v[160:175], v[136:139], v[36:39], v[160:175]
    v_mfma_f32_32x32x16_bf16 v[176:191], v[140:143], v[36:39], v[176:191]
    s_waitcnt lgkmcnt(5)
    v_mfma_f32_32x32x16_bf16 v[160:175], v[144:147], v[40:43], v[160:175]
    v_mfma_f32_32x32x16_bf16 v[176:191], v[148:151], v[40:43], v[176:191]
    s_cmp_le_u32 s62, 11
    s_cbranch_scc1 L_lt_23
    s_add_u32 s33, s43, 90112
    buffer_load_dwordx4 v[252:255], v4, s[8:11], s33 offen nt
L_lt_23:
    s_waitcnt lgkmcnt(0)
    s_barrier
    v_mfma_f32_32x32x16_bf16 v[160:175], v[152:155], v[44:47], v[160:175]
    v_mfma_f32_32x32x16_bf16 v[176:191], v[156:159], v[44:47], v[176:191]
    s_waitcnt vmcnt(8)
    s_cmp_eq_u32 s62, 12
    s_cbranch_scc1 L_mid
    s_waitcnt vmcnt(6)
    s_cmp_eq_u32 s62, 10
    s_cbranch_scc1 L_mid
    s_waitcnt vmcnt(4)
    s_cmp_eq_u32 s62, 8
    s_cbranch_scc1 L_mid
    s_waitcnt vmcnt(2)
    s_cmp_eq_u32 s62, 6
    s_cbranch_scc1 L_mid
    s_waitcnt vmcnt(0)
L_mid:
    ds_write_b128 v19, v[192:195] offset:0
    ds_write_b128 v19, v[196:199] offset:8192
    ds_write_b128 v19, v[200:203] offset:32768
    ds_write_b128 v19, v[204:207] offset:40960
    ds_write_b128 v62, v[208:211] offset:0
    ds_write_b128 v62, v[212:215] offset:8192
    ds_write_b128 v62, v[216:219] offset:32768
    ds_write_b128 v62, v[220:223] offset:40960
    s_lshl_b32 s50, s55, 15
    s_lshl_b32 s36, s54, 12
    s_add_u32 s50, s50, s36
    s_add_u32 s50, s50, 16384
    v_and_b32 v7, 31, v0
    v_and_b32 v8, 7, v0
    v_lshlrev_b32 v9, 4, v8
    v_lshl_add_u32 v9, v7, 7, v9
    v_lshrrev_b32 v10, 5, v0
    v_lshl_add_u32 v9, v10, 3, v9
    v_add_u32 v3, s50, v9
    v_lshrrev_b32 v10, 3, v0
    v_xor_b32 v11, v8, v10
    v_lshlrev_b32 v11, 4, v11
    v_lshl_add_u32 v11, v10, 7, v11
    v_add_u32 v4, s50, v11
    v_lshlrev_b32 v12, 4, v8
    v_lshl_add_u32 v29, v10, 16, v12
    v_lshlrev_b32 v17, 10, v0
    v_mov_b32 v18, 0x10001
    s_mov_b32 s51, 0x07060302
    v_mov_b32 v54, s32
    v_mov_b32 v55, s32
    s_lshl_b32 s49, s55, 15
    s_lshl_b32 s36, s6, 14
    s_add_u32 s49, s49, s36
    s_lshl_b32 s36, s4, 9
    s_add_u32 s49, s49, s36
    s_lshl_b32 s36, s54, 7
    s_add_u32 s49, s49, s36
    s_add_u32 s49, s49, 1048576
    s_lshl_b32 s53, s6, 9
    s_lshl_b32 s36, s4, 4
    s_add_u32 s53, s53, s36
    s_add_u32 s53, s53, 327680
    s_bfe_u32 s33, s32, 0x20000
    s_mul_i32 s33, s33, 0x8001
    s_and_b32 s56, s33, 0x10001
    s_bfe_u32 s33, s32, 0x20002
    s_mul_i32 s33, s33, 0x8001
    s_and_b32 s57, s33, 0x10001
    s_bfe_u32 s33, s32, 0x20004
    s_mul_i32 s33, s33, 0x8001
    s_and_b32 s58, s33, 0x10001
    s_bfe_u32 s33, s32, 0x20006
    s_mul_i32 s33, s33, 0x8001
    s_and_b32 s59, s33, 0x10001
    s_waitcnt lgkmcnt(0)
    s_barrier
    buffer_load_dwordx4 v[192:195], v5, s[16:19], s45 offen nt
    s_add_u32 s45, s45, 32768
    buffer_load_dwordx4 v[196:199], v6, s[16:19], s45 offen nt
    s_add_u32 s45, s45, 32768
    buffer_load_dwordx4 v[200:203], v5, s[16:19], s45 offen nt
    s_add_u32 s45, s45, 32768
    buffer_load_dwordx4 v[204:207], v6, s[16:19], s45 offen nt
    s_add_u32 s45, s45, 32768
    v_xor_b32 v7, 0, v28
    ds_read_b128 v[128:131], v7 offset:0
    v_xor_b32 v7, 16, v28
    ds_read_b128 v[132:135], v7 offset:0
    v_xor_b32 v7, 32, v28
    ds_read_b128 v[136:139], v7 offset:0
    v_xor_b32 v7, 48, v28
    ds_read_b128 v[140:143], v7 offset:0
    v_xor_b32 v7, 64, v28
    ds_read_b128 v[144:147], v7 offset:0
    v_xor_b32 v7, 80, v28
    ds_read_b128 v[148:151], v7 offset:0
    v_xor_b32 v7, 96, v28
    ds_read_b128 v[152:155], v7 offset:0
    v_xor_b32 v7, 112, v28
    ds_read_b128 v[156:159], v7 offset:0
    s_waitcnt lgkmcnt(7)
    v_mfma_f32_16x16x32_bf16 v[48:51], v[128:131], v[64:67], 0
    v_xor_b32 v7, 128, v28
    ds_read_b128 v[128:131], v7 offset:0
    s_waitcnt lgkmcnt(7)
    v_mfma_f32_16x16x32_bf16 v[48:51], v[132:135], v[68:71], v[48:51]
    v_xor_b32 v7, 144, v28
    ds_read_b128 v[132:135], v7 offset:0
    s_waitcnt lgkmcnt(7)
    v_mfma_f32_16x16x32_bf16 v[48:51], v[136:139], v[72:75], v[48:51]
    v_xor_b32 v7, 160, v28
    ds_read_b128 v[136:139], v7 offset:0
    s_waitcnt lgkmcnt(7)
    v_mfma_f32_16x16x32_bf16 v[48:51], v[140:143], v[76:79], v[48:51]
    v_xor_b32 v7, 176, v28
    ds_read_b128 v[140:143], v7 offset:0
    s_waitcnt lgkmcnt(7)
    v_mfma_f32_16x16x32_bf16 v[48:51], v[144:147], v[80:83], v[48:51]
    v_xor_b32 v7, 192, v28
    ds_read_b128 v[144:147], v7 offset:0
    s_waitcnt lgkmcnt(7)
    v_mfma_f32_16x16x32_bf16 v[48:51], v[148:151], v[84:87], v[48:51]
    v_xor_b32 v7, 208, v28
    ds_read_b128 v[148:151], v7 offset:0
    s_waitcnt lgkmcnt(7)
    v_mfma_f32_16x16x32_bf16 v[48:51], v[152:155], v[88:91], v[48:51]
    v_xor_b32 v7, 224, v28
    ds_read_b128 v[152:155], v7 offset:0
    s_waitcnt lgkmcnt(7)
    v_mfma_f32_16x16x32_bf16 v[48:51], v[156:159], v[92:95], v[48:51]
    v_xor_b32 v7, 240, v28
    ds_read_b128 v[156:159], v7 offset:0
    s_waitcnt lgkmcnt(7)
    v_mfma_f32_16x16x32_bf16 v[48:51], v[128:131], v[96:99], v[48:51]
    s_waitcnt lgkmcnt(6)
    v_mfma_f32_16x16x32_bf16 v[48:51], v[132:135], v[100:103], v[48:51]
    s_waitcnt lgkmcnt(5)
    v_mfma_f32_16x16x32_bf16 v[48:51], v[136:139], v[104:107], v[48:51]
    s_waitcnt lgkmcnt(4)
    v_mfma_f32_16x16x32_bf16 v[48:51], v[140:143], v[108:111], v[48:51]
    s_waitcnt lgkmcnt(3)
    v_mfma_f32_16x16x32_bf16 v[48:51], v[144:147], v[112:115], v[48:51]
    s_waitcnt lgkmcnt(2)
    v_mfma_f32_16x16x32_bf16 v[48:51], v[148:151], v[116:119], v[48:51]
    s_waitcnt lgkmcnt(1)
    v_mfma_f32_16x16x32_bf16 v[48:51], v[152:155], v[120:123], v[48:51]
    s_waitcnt lgkmcnt(0)
    v_mfma_f32_16x16x32_bf16 v[48:51], v[156:159], v[124:127], v[48:51]
    s_nop 7
    v_max3_f32 v7, v48, v49, v50
    v_max_f32 v7, v7, v51
    v_mov_b32 v8, v7
    s_nop 1
    v_permlane16_swap_b32 v8, v7
    v_max_f32 v7, v7, v8
    v_mov_b32 v8, v7
    s_nop 1
    v_permlane32_swap_b32 v8, v7
    v_max_f32 v7, v7, v8
    v_mul_f32 v7, s52, v7
    ds_write_b32 v31, v7
    ds_read_b64_tr_b16 v[128:129], v20 offset:0
    ds_read_b64_tr_b16 v[130:131], v21 offset:0
    ds_read_b64_tr_b16 v[132:133], v22 offset:0
    ds_read_b64_tr_b16 v[134:135], v23 offset:0
    ds_read_b64_tr_b16 v[136:137], v20 offset:32768
    ds_read_b64_tr_b16 v[138:139], v21 offset:32768
    ds_read_b64_tr_b16 v[140:141], v22 offset:32768
    ds_read_b64_tr_b16 v[142:143], v23 offset:32768
    ds_read_b64_tr_b16 v[144:145], v24 offset:0
    ds_read_b64_tr_b16 v[146:147], v25 offset:0
    ds_read_b64_tr_b16 v[148:149], v26 offset:0
    ds_read_b64_tr_b16 v[150:151], v27 offset:0
    s_waitcnt lgkmcnt(12)
    s_barrier
    ds_read_b128 v[8:11], v30
    ds_read_b128 v[12:15], v56
    s_waitcnt lgkmcnt(0)
    ds_read_b64_tr_b16 v[152:153], v24 offset:32768
    ds_read_b64_tr_b16 v[154:155], v25 offset:32768
    ds_read_b64_tr_b16 v[156:157], v26 offset:32768
    ds_read_b64_tr_b16 v[158:159], v27 offset:32768
    v_max3_f32 v8, v8, v9, v10
    v_max3_f32 v8, v8, v11, v57
    v_fma_f32 v48, v48, s52, -v8
    v_fma_f32 v49, v49, s52, -v8
    v_fma_f32 v50, v50, s52, -v8
    v_fma_f32 v51, v51, s52, -v8
    v_exp_f32 v48, v48
    v_exp_f32 v49, v49
    v_exp_f32 v50, v50
    v_exp_f32 v51, v51
    v_max3_f32 v12, v12, v13, v14
    v_cvt_pk_bf16_f32 v32, v48, v49
    v_cvt_pk_bf16_f32 v33, v50, v51
    ds_write_b64 v61, v[32:33] offset:0
    v_sub_f32 v9, v57, v8
    v_max3_f32 v12, v12, v15, v58
    v_exp_f32 v9, v9
    v_sub_f32 v14, v58, v12
    v_mov_b32 v57, v8
    v_exp_f32 v14, v14
    v_mov_b32 v58, v12
    v_pk_add_f32 v[48:49], v[48:49], v[50:51]
    v_fma_f32 v59, v59, v9, v48
    v_add_f32 v59, v59, v49
    v_pk_mul_f32 v[160:161], v[160:161], v[14:15] op_sel_hi:[1,0]
    v_pk_mul_f32 v[162:163], v[162:163], v[14:15] op_sel_hi:[1,0]
    v_pk_mul_f32 v[164:165], v[164:165], v[14:15] op_sel_hi:[1,0]
    v_pk_mul_f32 v[166:167], v[166:167], v[14:15] op_sel_hi:[1,0]
    v_pk_mul_f32 v[168:169], v[168:169], v[14:15] op_sel_hi:[1,0]
    v_pk_mul_f32 v[170:171], v[170:171], v[14:15] op_sel_hi:[1,0]
    s_waitcnt lgkmcnt(0)
    s_barrier
    ds_read_b128 v[32:35], v60 offset:0
    ds_read_b128 v[36:39], v60 offset:64
    ds_read_b128 v[40:43], v60 offset:128
    ds_read_b128 v[44:47], v60 offset:192
    v_pk_mul_f32 v[172:173], v[172:173], v[14:15] op_sel_hi:[1,0]
    v_pk_mul_f32 v[174:175], v[174:175], v[14:15] op_sel_hi:[1,0]
    v_pk_mul_f32 v[176:177], v[176:177], v[14:15] op_sel_hi:[1,0]
    v_pk_mul_f32 v[178:179], v[178:179], v[14:15] op_sel_hi:[1,0]
    v_pk_mul_f32 v[180:181], v[180:181], v[14:15] op_sel_hi:[1,0]
    v_pk_mul_f32 v[182:183], v[182:183], v[14:15] op_sel_hi:[1,0]
    v_pk_mul_f32 v[184:185], v[184:185], v[14:15] op_sel_hi:[1,0]
    v_pk_mul_f32 v[186:187], v[186:187], v[14:15] op_sel_hi:[1,0]
    v_pk_mul_f32 v[188:189], v[188:189], v[14:15] op_sel_hi:[1,0]
    v_pk_mul_f32 v[190:191], v[190:191], v[14:15] op_sel_hi:[1,0]
    s_waitcnt lgkmcnt(3)
    v_mfma_f32_32x32x16_bf16 v[160:175], v[128:131], v[32:35], v[160:175]
    v_mfma_f32_32x32x16_bf16 v[176:191], v[132:135], v[32:35], v[176:191]
    buffer_load_dwordx4 v[208:211], v5, s[16:19], s45 offen nt
    s_add_u32 s45, s45, 32768
    s_waitcnt lgkmcnt(2)
    v_mfma_f32_32x32x16_bf16 v[160:175], v[136:139], v[36:39], v[160:175]
    v_mfma_f32_32x32x16_bf16 v[176:191], v[140:143], v[36:39], v[176:191]
    buffer_load_dwordx4 v[212:215], v6, s[16:19], s45 offen nt
    s_add_u32 s45, s45, 32768
    s_waitcnt lgkmcnt(1)
    v_mfma_f32_32x32x16_bf16 v[160:175], v[144:147], v[40:43], v[160:175]
    v_mfma_f32_32x32x16_bf16 v[176:191], v[148:151], v[40:43], v[176:191]
    buffer_load_dwordx4 v[216:219], v5, s[16:19], s45 offen nt
    s_add_u32 s45, s45, 32768
    s_waitcnt lgkmcnt(0)
    v_mfma_f32_32x32x16_bf16 v[160:175], v[152:155], v[44:47], v[160:175]
    v_mfma_f32_32x32x16_bf16 v[176:191], v[156:159], v[44:47], v[176:191]
    buffer_load_dwordx4 v[220:223], v6, s[16:19], s45 offen nt
    s_add_u32 s45, s45, 32768
    s_waitcnt vmcnt(8)
    ds_write_b128 v19, v[224:227] offset:16384
    ds_write_b128 v19, v[228:231] offset:24576
    ds_write_b128 v19, v[232:235] offset:49152
    ds_write_b128 v19, v[236:239] offset:57344
    ds_write_b128 v62, v[240:243] offset:16384
    ds_write_b128 v62, v[244:247] offset:24576
    ds_write_b128 v62, v[248:251] offset:49152
    ds_write_b128 v62, v[252:255] offset:57344
    s_waitcnt lgkmcnt(0)
    s_barrier
    v_xor_b32 v7, 0, v28
    ds_read_b128 v[128:131], v7 offset:16384
    v_xor_b32 v7, 16, v28
    ds_read_b128 v[132:135], v7 offset:16384
    v_xor_b32 v7, 32, v28
    ds_read_b128 v[136:139], v7 offset:16384
    v_xor_b32 v7, 48, v28
    ds_read_b128 v[140:143], v7 offset:16384
    v_xor_b32 v7, 64, v28
    ds_read_b128 v[144:147], v7 offset:16384
    v_xor_b32 v7, 80, v28
    ds_read_b128 v[148:151], v7 offset:16384
    v_xor_b32 v7, 96, v28
    ds_read_b128 v[152:155], v7 offset:16384
    v_xor_b32 v7, 112, v28
    ds_read_b128 v[156:159], v7 offset:16384
    s_waitcnt lgkmcnt(7)
    v_mfma_f32_16x16x32_bf16 v[48:51], v[128:131], v[64:67], 0
    v_xor_b32 v7, 128, v28
    ds_read_b128 v[128:131], v7 offset:16384
    s_waitcnt lgkmcnt(7)
    v_mfma_f32_16x16x32_bf16 v[48:51], v[132:135], v[68:71], v[48:51]
    v_xor_b32 v7, 144, v28
    ds_read_b128 v[132:135], v7 offset:16384
    s_waitcnt lgkmcnt(7)
    v_mfma_f32_16x16x32_bf16 v[48:51], v[136:139], v[72:75], v[48:51]
    v_xor_b32 v7, 160, v28
    ds_read_b128 v[136:139], v7 offset:16384
    s_waitcnt lgkmcnt(7)
    v_mfma_f32_16x16x32_bf16 v[48:51], v[140:143], v[76:79], v[48:51]
    v_xor_b32 v7, 176, v28
    ds_read_b128 v[140:143], v7 offset:16384
    s_waitcnt lgkmcnt(7)
    v_mfma_f32_16x16x32_bf16 v[48:51], v[144:147], v[80:83], v[48:51]
    v_xor_b32 v7, 192, v28
    ds_read_b128 v[144:147], v7 offset:16384
    s_waitcnt lgkmcnt(7)
    v_mfma_f32_16x16x32_bf16 v[48:51], v[148:151], v[84:87], v[48:51]
    v_xor_b32 v7, 208, v28
    ds_read_b128 v[148:151], v7 offset:16384
    s_waitcnt lgkmcnt(7)
    v_mfma_f32_16x16x32_bf16 v[48:51], v[152:155], v[88:91], v[48:51]
    v_xor_b32 v7, 224, v28
    ds_read_b128 v[152:155], v7 offset:16384
    s_waitcnt lgkmcnt(7)
    v_mfma_f32_16x16x32_bf16 v[48:51], v[156:159], v[92:95], v[48:51]
    v_xor_b32 v7, 240, v28
    ds_read_b128 v[156:159], v7 offset:16384
    s_waitcnt lgkmcnt(7)
    v_mfma_f32_16x16x32_bf16 v[48:51], v[128:131], v[96:99], v[48:51]
    s_waitcnt lgkmcnt(6)
    v_mfma_f32_16x16x32_bf16 v[48:51], v[132:135], v[100:103], v[48:51]
    s_waitcnt lgkmcnt(5)
    v_mfma_f32_16x16x32_bf16 v[48:51], v[136:139], v[104:107], v[48:51]
    s_waitcnt lgkmcnt(4)
    v_mfma_f32_16x16x32_bf16 v[48:51], v[140:143], v[108:111], v[48:51]
    s_waitcnt lgkmcnt(3)
    v_mfma_f32_16x16x32_bf16 v[48:51], v[144:147], v[112:115], v[48:51]
    s_waitcnt lgkmcnt(2)
    v_mfma_f32_16x16x32_bf16 v[48:51], v[148:151], v[116:119], v[48:51]
    s_waitcnt lgkmcnt(1)
    v_mfma_f32_16x16x32_bf16 v[48:51], v[152:155], v[120:123], v[48:51]
    s_waitcnt lgkmcnt(0)
    v_mfma_f32_16x16x32_bf16 v[48:51], v[156:159], v[124:127], v[48:51]
    s_nop 7
    v_max3_f32 v7, v48, v49, v50
    v_max_f32 v7, v7, v51
    v_mov_b32 v8, v7
    s_nop 1
    v_permlane16_swap_b32 v8, v7
    v_max_f32 v7, v7, v8
    v_mov_b32 v8, v7
    s_nop 1
    v_permlane32_swap_b32 v8, v7
    v_max_f32 v7, v7, v8
    v_mul_f32 v7, s52, v7
    ds_write_b32 v31, v7
    ds_read_b64_tr_b16 v[128:129], v20 offset:16384
    ds_read_b64_tr_b16 v[130:131], v21 offset:16384
    ds_read_b64_tr_b16 v[132:133], v22 offset:16384
    ds_read_b64_tr_b16 v[134:135], v23 offset:16384
    ds_read_b64_tr_b16 v[136:137], v20 offset:49152
    ds_read_b64_tr_b16 v[138:139], v21 offset:49152
    ds_read_b64_tr_b16 v[140:141], v22 offset:49152
    ds_read_b64_tr_b16 v[142:143], v23 offset:49152
    ds_read_b64_tr_b16 v[144:145], v24 offset:16384
    ds_read_b64_tr_b16 v[146:147], v25 offset:16384
    ds_read_b64_tr_b16 v[148:149], v26 offset:16384
    ds_read_b64_tr_b16 v[150:151], v27 offset:16384
    s_waitcnt lgkmcnt(12)
    s_barrier
    ds_read_b128 v[8:11], v30
    ds_read_b128 v[12:15], v56
    s_waitcnt lgkmcnt(0)
    ds_read_b64_tr_b16 v[152:153], v24 offset:49152
    ds_read_b64_tr_b16 v[154:155], v25 offset:49152
    ds_read_b64_tr_b16 v[156:157], v26 offset:49152
    ds_read_b64_tr_b16 v[158:159], v27 offset:49152
    v_max3_f32 v8, v8, v9, v10
    v_max3_f32 v8, v8, v11, v57
    v_fma_f32 v48, v48, s52, -v8
    v_fma_f32 v49, v49, s52, -v8
    v_fma_f32 v50, v50, s52, -v8
    v_fma_f32 v51, v51, s52, -v8
    v_exp_f32 v48, v48
    v_exp_f32 v49, v49
    v_exp_f32 v50, v50
    v_exp_f32 v51, v51
    v_max3_f32 v12, v12, v13, v14
    v_cvt_pk_bf16_f32 v32, v48, v49
    v_cvt_pk_bf16_f32 v33, v50, v51
    ds_write_b64 v61, v[32:33] offset:32
    v_sub_f32 v9, v57, v8
    v_max3_f32 v12, v12, v15, v58
    v_exp_f32 v9, v9
    v_sub_f32 v14, v58, v12
    v_mov_b32 v57, v8
    v_exp_f32 v14, v14
    v_mov_b32 v58, v12
    v_pk_add_f32 v[48:49], v[48:49], v[50:51]
    v_fma_f32 v59, v59, v9, v48
    v_add_f32 v59, v59, v49
    v_mov_b32 v8, v59
    s_nop 1
    v_permlane16_swap_b32 v8, v59
    v_add_f32 v59, v59, v8
    v_mov_b32 v8, v59
    s_nop 1
    v_permlane32_swap_b32 v8, v59
    v_add_f32 v59, v59, v8
    ds_write_b32 v31, v59 offset:512
    v_pk_mul_f32 v[160:161], v[160:161], v[14:15] op_sel_hi:[1,0]
    v_pk_mul_f32 v[162:163], v[162:163], v[14:15] op_sel_hi:[1,0]
    v_pk_mul_f32 v[164:165], v[164:165], v[14:15] op_sel_hi:[1,0]
    v_pk_mul_f32 v[166:167], v[166:167], v[14:15] op_sel_hi:[1,0]
    v_pk_mul_f32 v[168:169], v[168:169], v[14:15] op_sel_hi:[1,0]
    v_pk_mul_f32 v[170:171], v[170:171], v[14:15] op_sel_hi:[1,0]
    s_waitcnt lgkmcnt(0)
    s_barrier
    ds_read_b128 v[32:35], v60 offset:32
    ds_read_b128 v[36:39], v60 offset:96
    ds_read_b128 v[40:43], v60 offset:160
    ds_read_b128 v[44:47], v60 offset:224
    v_pk_mul_f32 v[172:173], v[172:173], v[14:15] op_sel_hi:[1,0]
    v_pk_mul_f32 v[174:175], v[174:175], v[14:15] op_sel_hi:[1,0]
    v_pk_mul_f32 v[176:177], v[176:177], v[14:15] op_sel_hi:[1,0]
    v_pk_mul_f32 v[178:179], v[178:179], v[14:15] op_sel_hi:[1,0]
    v_pk_mul_f32 v[180:181], v[180:181], v[14:15] op_sel_hi:[1,0]
    v_pk_mul_f32 v[182:183], v[182:183], v[14:15] op_sel_hi:[1,0]
    v_pk_mul_f32 v[184:185], v[184:185], v[14:15] op_sel_hi:[1,0]
    v_pk_mul_f32 v[186:187], v[186:187], v[14:15] op_sel_hi:[1,0]
    v_pk_mul_f32 v[188:189], v[188:189], v[14:15] op_sel_hi:[1,0]
    v_pk_mul_f32 v[190:191], v[190:191], v[14:15] op_sel_hi:[1,0]
    s_waitcnt lgkmcnt(3)
    v_mfma_f32_32x32x16_bf16 v[160:175], v[128:131], v[32:35], v[160:175]
    v_mfma_f32_32x32x16_bf16 v[176:191], v[132:135], v[32:35], v[176:191]
    s_waitcnt lgkmcnt(2)
    v_mfma_f32_32x32x16_bf16 v[160:175], v[136:139], v[36:39], v[160:175]
    v_mfma_f32_32x32x16_bf16 v[176:191], v[140:143], v[36:39], v[176:191]
    s_waitcnt lgkmcnt(1)
    v_mfma_f32_32x32x16_bf16 v[160:175], v[144:147], v[40:43], v[160:175]
    v_mfma_f32_32x32x16_bf16 v[176:191], v[148:151], v[40:43], v[176:191]
    s_waitcnt lgkmcnt(0)
    v_mfma_f32_32x32x16_bf16 v[160:175], v[152:155], v[44:47], v[160:175]
    v_mfma_f32_32x32x16_bf16 v[176:191], v[156:159], v[44:47], v[176:191]
    v_xor_b32 v225, 16, v3
    v_xor_b32 v226, 32, v3
    v_xor_b32 v227, 48, v3
    v_xor_b32 v228, 64, v3
    v_xor_b32 v229, 80, v3
    v_xor_b32 v230, 96, v3
    v_xor_b32 v231, 112, v3
    s_nop 5
    v_perm_b32 v128, v161, v160, s51
    v_perm_b32 v129, v163, v162, s51
    ds_write_b64 v3, v[128:129]
    v_perm_b32 v130, v165, v164, s51
    v_perm_b32 v131, v167, v166, s51
    ds_write_b64 v225, v[130:131]
    v_perm_b32 v132, v169, v168, s51
    v_perm_b32 v133, v171, v170, s51
    ds_write_b64 v226, v[132:133]
    v_perm_b32 v134, v173, v172, s51
    v_perm_b32 v135, v175, v174, s51
    ds_write_b64 v227, v[134:135]
    v_perm_b32 v136, v177, v176, s51
    v_perm_b32 v137, v179, v178, s51
    ds_write_b64 v228, v[136:137]
    v_perm_b32 v138, v181, v180, s51
    v_perm_b32 v139, v183, v182, s51
    ds_write_b64 v229, v[138:139]
    v_perm_b32 v140, v185, v184, s51
    v_perm_b32 v141, v187, v186, s51
    ds_write_b64 v230, v[140:141]
    v_perm_b32 v142, v189, v188, s51
    v_perm_b32 v143, v191, v190, s51
    ds_write_b64 v231, v[142:143]
    ds_read_b128 v[144:147], v4 offset:0
    ds_read_b128 v[148:151], v4 offset:1024
    ds_read_b128 v[152:155], v4 offset:2048
    ds_read_b128 v[156:159], v4 offset:3072
    s_waitcnt lgkmcnt(3)
    v_bfi_b32 v144, v18, s56, v144
    v_bfi_b32 v145, v18, s57, v145
    v_bfi_b32 v146, v18, s58, v146
    v_bfi_b32 v147, v18, s59, v147
    buffer_store_dwordx4 v[144:147], v29, s[12:15], s49 offen sc1
    s_add_u32 s49, s49, 524288
    s_waitcnt lgkmcnt(2)
    v_bfi_b32 v148, v18, s56, v148
    v_bfi_b32 v149, v18, s57, v149
    v_bfi_b32 v150, v18, s58, v150
    v_bfi_b32 v151, v18, s59, v151
    buffer_store_dwordx4 v[148:151], v29, s[12:15], s49 offen sc1
    s_add_u32 s49, s49, 524288
    s_waitcnt lgkmcnt(1)
    v_bfi_b32 v152, v18, s56, v152
    v_bfi_b32 v153, v18, s57, v153
    v_bfi_b32 v154, v18, s58, v154
    v_bfi_b32 v155, v18, s59, v155
    buffer_store_dwordx4 v[152:155], v29, s[12:15], s49 offen sc1
    s_add_u32 s49, s49, 524288
    s_waitcnt lgkmcnt(0)
    v_bfi_b32 v156, v18, s56, v156
    v_bfi_b32 v157, v18, s57, v157
    v_bfi_b32 v158, v18, s58, v158
    v_bfi_b32 v159, v18, s59, v159
    buffer_store_dwordx4 v[156:159], v29, s[12:15], s49 offen sc1
    s_add_u32 s49, s49, 524288
    s_cmp_lg_u32 s3, 0
    s_cbranch_scc1 L_nost
    ds_read_b128 v[8:11], v56 offset:512
    v_mov_b32 v52, v58
    s_waitcnt lgkmcnt(0)
    v_add_f32 v8, v8, v9
    v_add_f32 v10, v10, v11
    v_add_f32 v53, v8, v10
    s_mov_b32 exec_lo, 0xffffffff
    s_mov_b32 exec_hi, 0x0
    buffer_store_dwordx4 v[52:55], v17, s[12:15], s53 offen sc1
    s_mov_b64 exec, -1
L_nost:
    v_lshrrev_b32 v9, 3, v0
    v_and_b32 v10, 7, v0
    v_and_b32 v11, 1, v2
    v_lshlrev_b32 v11, 1, v11
    v_xor_b32 v10, v10, v11
    v_lshlrev_b32 v10, 4, v10
    v_lshl_add_u32 v17, v9, 10, v10
    v_xor_b32 v18, 64, v17
    s_and_b32 s33, s3, 3
    s_lshl_b32 s46, s4, 17
    s_lshl_b32 s36, s33, 15
    s_add_u32 s46, s46, s36
    s_cmp_lt_u32 s3, 4
    s_cselect_b32 s36, 0, 0
    s_xor_b32 s36, s36, s5
    s_lshl_b32 s36, s36, 7
    s_add_u32 s46, s46, s36
    s_cmp_lt_u32 s3, 4
    s_mov_b32 s47, 114688
    s_cmov_b32 s47, 81920
    s_lshl_b32 s36, s33, 12
    s_add_u32 s47, s47, s36
    s_lshl_b32 s33, s4, 10
    s_lshl_b32 s36, s3, 7
    s_add_u32 s33, s33, s36
    s_add_u32 s33, s33, 327680
    s_add_u32 s34, s12, s33
    s_addc_u32 s35, s13, 0
    v_lshrrev_b32 v7, 5, v0
    s_and_b32 s33, s3, 1
    s_lshl_b32 s33, s33, 2
    v_or_b32 v7, s33, v7
    v_lshlrev_b32 v7, 5, v7
    v_xor_b32 v3, v7, v16
    v_xor_b32 v4, 64, v3
    s_lshl_b32 s49, s4, 16
    s_lshl_b32 s36, s6, 15
    s_add_u32 s49, s49, s36
    s_lshl_b32 s36, s3, 12
    s_add_u32 s49, s49, s36
    s_add_u32 s49, s49, 1048576
    v_add_u32 v5, s50, v16
    v_lshrrev_b32 v8, 2, v1
    v_lshrrev_b32 v9, 1, v2
    v_and_b32 v10, 1, v2
    v_lshlrev_b32 v7, 15, v9
    v_lshl_add_u32 v7, v10, 13, v7
    v_lshl_add_u32 v7, v8, 8, v7
    v_and_b32 v11, 3, v0
    v_lshl_add_u32 v7, v11, 3, v7
    v_lshl_or_b32 v10, v10, 2, v8
    v_xor_b32 v9, s3, v10
    v_lshl_add_u32 v20, v9, 5, v7
    v_add_u32 v21, 65536, v20
    v_lshlrev_b32 v7, 12, v2
    v_lshl_add_u32 v7, v8, 9, v7
    v_lshl_add_u32 v7, v11, 3, v7
    s_lshl_b32 s33, s3, 1
    v_xor_b32 v10, s33, v10
    v_lshl_add_u32 v7, v10, 5, v7
    v_add_u32 v24, 16384, v7
    v_xor_b32 v25, 32, v24
    s_lshl_b32 s33, s3, 7
    s_add_u32 s36, s33, 160768
    v_lshl_add_u32 v22, v0, 1, s36
    v_and_b32 v8, 1, v0
    v_lshlrev_b32 v7, 6, v8
    v_lshl_add_u32 v7, v2, 4, v7
    v_add_u32 v23, s36, v7
    v_add_u32 v27, 161792, v7
    v_add_u32 v26, s33, v27
    v_lshlrev_b32 v7, 11, v8
    v_lshl_add_u32 v28, v2, 4, v7
    s_lshl_b32 s53, s4, 12
    s_lshl_b32 s36, s6, 9
    s_add_u32 s53, s53, s36
    s_lshl_b32 s36, s3, 6
    s_add_u32 s53, s53, s36
    s_add_u32 s53, s53, 524288
    s_add_u32 s36, s36, 159744
    v_lshl_add_u32 v29, v0, 3, s36
    v_lshlrev_b32 v30, 3, v0
    v_add_u32 v30, 159744, v30
    v_and_b32 v7, 1, v2
    v_cvt_f32_u32 v54, v7
    v_mul_f32 v54, 0.5, v54
    s_load_dwordx2 s[28:29], s[0:1], 88
    v_lshrrev_b32 v9, 2, v1
    v_lshlrev_b32 v7, 10, v2
    v_lshl_add_u32 v7, v9, 7, v7
    v_and_b32 v10, 3, v0
    v_lshl_add_u32 v7, v10, 3, v7
    v_lshrrev_b32 v9, 1, v9
    v_and_b32 v8, 1, v2
    v_lshl_or_b32 v9, v8, 1, v9
    s_and_b32 s33, s3, 3
    v_xor_b32 v9, s33, v9
    v_lshl_add_u32 v7, v9, 5, v7
    s_cmp_lt_u32 s3, 4
    s_mov_b32 s36, 114688
    s_cmov_b32 s36, 81920
    s_mov_b32 s40, 524288
    s_cmov_b32 s40, 393216
    v_add_u32 v244, s36, v7
    s_lshl_b32 s36, s4, 12
    s_add_u32 s40, s40, s36
    s_lshl_b32 s36, s33, 9
    s_add_u32 s40, s40, s36
    v_lshrrev_b32 v9, 5, v0
    v_mul_u32_u24 v245, 1536, v9
    v_add_u32 v245, v245, v16
    s_and_b32 s36, s3, 4
    s_lshl_b32 s36, s36, 1
    s_add_u32 s33, s36, s33
    v_lshl_add_u32 v9, v9, 2, s33
    v_and_b32 v8, 31, v0
    v_mul_u32_u24 v246, 272, v9
    v_lshl_add_u32 v246, v8, 3, v246
    v_add_u32 v246, 151552, v246
    v_mul_u32_u24 v247, 136, v9
    v_lshl_add_u32 v247, v8, 2, v247
    v_add_u32 v247, 156160, v247
    v_and_b32 v9, 7, v0
    v_add_u32 v9, s36, v9
    v_mul_u32_u24 v248, 272, v9
    v_lshl_add_u32 v248, v2, 4, v248
    v_add_u32 v248, 151552, v248
    v_mul_u32_u24 v249, 136, v9
    v_add_u32 v249, 156160, v249
    v_mov_b32 v240, 0
    v_mov_b32 v241, 0
    v_and_b32 v8, 1, v0
    v_add_u32 v8, -1, v8
    v_and_b32 v242, 0xff7fffff, v8
    s_mov_b32 s30, 4096
    s_mov_b32 s31, 0x20000
    v_lshlrev_b32 v250, 12, v2
    v_lshl_add_u32 v250, v1, 2, v250
    s_cmp_lt_u32 s3, 4
    s_cselect_b32 s41, 0, 0
    s_xor_b32 s41, s41, s5
    s_lshl_b32 s41, s41, 3
    s_add_u32 s41, s41, s3
    s_lshr_b32 s41, s41, 1
    s_lshl_b32 s41, s41, 13
    s_and_b32 s36, s3, 1
    s_lshl_b32 s36, s36, 6
    s_add_u32 s41, s41, s36
    v_mov_b32 v251, 0xff
    s_lshl_b32 s36, s4, 7
    s_add_u32 s41, s41, s36
    s_add_u32 s41, s41, 4194304
    v_mov_b32 v253, s32
    s_xor_b32 s38, s5, 0
    s_lshl_b32 s42, s38, 2
    s_lshr_b32 s36, s4, 3
    s_add_u32 s42, s42, s36
    s_lshl_b32 s42, s42, 1
    s_bfe_u32 s36, s4, 0x10001
    s_add_u32 s42, s42, s36
    s_lshl_b32 s42, s42, 12
    s_and_b32 s33, s4, 1
    s_lshl_b32 s43, s33, 6
    s_add_u32 s42, s42, s43
    s_add_u32 s42, s42, 4194304
    s_lshl_b32 s43, s33, 4
    s_and_b32 s36, s36, 1
    s_lshl_b32 s36, s36, 11
    s_add_u32 s43, s43, s36
    s_lshr_b32 s36, s4, 4
    s_lshl_b32 s36, s36, 10
    s_add_u32 s43, s43, s36
    s_lshl_b32 s36, s38, 7
    s_add_u32 s43, s43, s36
    s_bfe_u32 s36, s4, 0x20002
    s_lshl_b32 s36, s36, 5
    s_add_u32 s43, s43, s36
    v_lshlrev_b32 v254, 3, v0
    v_and_b32 v8, 1, v0
    s_add_u32 s33, s6, 8
    v_lshl_add_u32 v8, v8, 2, s33
    v_lshl_add_u32 v9, s3, 2, v2
    s_add_u32 s33, s6, 4
    s_cmp_eq_u32 s3, s33
    s_cselect_b64 s[60:61], 0, -1
    v_mul_u32_u24 v238, 272, v8
    v_lshl_add_u32 v238, v9, 3, v238
    v_add_u32 v238, 151552, v238
    v_mul_u32_u24 v239, 136, v8
    v_lshl_add_u32 v239, v9, 2, v239
    v_add_u32 v239, 156160, v239
    s_mov_b32 s37, 262144
L_h3:
    s_load_dwordx16 s[64:79], s[34:35], 0 glc
    s_load_dwordx16 s[80:95], s[34:35], 64 glc
    s_sub_u32 s37, s37, 1
    s_waitcnt lgkmcnt(0)
    s_cbranch_scc1 L_h3ok
    s_cmp_lg_u32 s66, s32
    s_cbranch_scc1 L_h3
    s_cmp_lg_u32 s70, s32
    s_cbranch_scc1 L_h3
    s_cmp_lg_u32 s74, s32
    s_cbranch_scc1 L_h3
    s_cmp_lg_u32 s78, s32
    s_cbranch_scc1 L_h3
    s_cmp_lg_u32 s82, s32
    s_cbranch_scc1 L_h3
    s_cmp_lg_u32 s86, s32
    s_cbranch_scc1 L_h3
    s_cmp_lg_u32 s90, s32
    s_cbranch_scc1 L_h3
    s_cmp_lg_u32 s94, s32
    s_cbranch_scc1 L_h3
L_h3ok:
    buffer_load_dwordx4 v[160:163], v3, s[12:15], s49 offen offset:0 sc1
    buffer_load_dwordx4 v[164:167], v4, s[12:15], s49 offen offset:1024 sc1
    buffer_load_dwordx4 v[168:171], v3, s[12:15], s49 offen offset:2048 sc1
    buffer_load_dwordx4 v[172:175], v4, s[12:15], s49 offen offset:3072 sc1
    s_waitcnt vmcnt(4)
    ds_write_b128 v19, v[192:195] offset:0
    ds_write_b128 v19, v[196:199] offset:8192
    ds_write_b128 v19, v[200:203] offset:32768
    ds_write_b128 v19, v[204:207] offset:40960
    ds_write_b128 v62, v[208:211] offset:0
    ds_write_b128 v62, v[212:215] offset:8192
    ds_write_b128 v62, v[216:219] offset:32768
    ds_write_b128 v62, v[220:223] offset:40960
    v_writelane_b32 v8, s64, 0
    v_writelane_b32 v9, s65, 0
    v_writelane_b32 v8, s68, 1
    v_writelane_b32 v9, s69, 1
    v_writelane_b32 v8, s72, 2
    v_writelane_b32 v9, s73, 2
    v_writelane_b32 v8, s76, 3
    v_writelane_b32 v9, s77, 3
    v_writelane_b32 v8, s80, 4
    v_writelane_b32 v9, s81, 4
    v_writelane_b32 v8, s84, 5
    v_writelane_b32 v9, s85, 5
    v_writelane_b32 v8, s88, 6
    v_writelane_b32 v9, s89, 6
    v_writelane_b32 v8, s92, 7
    v_writelane_b32 v9, s93, 7
    s_mov_b64 exec, 0xff
    ds_write_b64 v29, v[8:9]
    s_mov_b64 exec, -1
    s_waitcnt lgkmcnt(0)
    s_barrier
    ds_read_b64 v[12:13], v30
    ds_read_b64_tr_b16 v[64:65], v20 offset:0
    ds_read_b64_tr_b16 v[66:67], v21 offset:0
    ds_read_b64_tr_b16 v[68:69], v20 offset:1024
    ds_read_b64_tr_b16 v[70:71], v21 offset:1024
    ds_read_b64_tr_b16 v[72:73], v20 offset:2048
    ds_read_b64_tr_b16 v[74:75], v21 offset:2048
    ds_read_b64_tr_b16 v[76:77], v20 offset:3072
    ds_read_b64_tr_b16 v[78:79], v21 offset:3072
    ds_read_b64_tr_b16 v[80:81], v20 offset:4096
    ds_read_b64_tr_b16 v[82:83], v21 offset:4096
    ds_read_b64_tr_b16 v[84:85], v20 offset:5120
    ds_read_b64_tr_b16 v[86:87], v21 offset:5120
    ds_read_b64_tr_b16 v[88:89], v20 offset:6144
    ds_read_b64_tr_b16 v[90:91], v21 offset:6144
    s_waitcnt lgkmcnt(14)
    v_mov_b32 v14, v12
    s_nop 1
    v_max_f32_dpp v14, v14, v14 row_ror:1 row_mask:0xf bank_mask:0xf
    s_nop 1
    v_max_f32_dpp v14, v14, v14 row_ror:2 row_mask:0xf bank_mask:0xf
    s_nop 1
    v_max_f32_dpp v14, v14, v14 row_ror:4 row_mask:0xf bank_mask:0xf
    s_nop 1
    v_max_f32_dpp v14, v14, v14 row_ror:8 row_mask:0xf bank_mask:0xf
    v_mov_b32 v15, v14
    s_nop 1
    v_permlane16_swap_b32 v15, v14
    v_max_f32 v14, v14, v15
    ds_read_b64_tr_b16 v[92:93], v20 offset:7168
    ds_read_b64_tr_b16 v[94:95], v21 offset:7168
    v_sub_f32 v12, v12, v14
    v_exp_f32 v12, v12
    s_nop 0
    v_mul_f32 v13, v12, v13
    s_nop 1
    v_add_f32_dpp v13, v13, v13 row_ror:1 row_mask:0xf bank_mask:0xf
    s_nop 1
    v_add_f32_dpp v13, v13, v13 row_ror:2 row_mask:0xf bank_mask:0xf
    s_nop 1
    v_add_f32_dpp v13, v13, v13 row_ror:4 row_mask:0xf bank_mask:0xf
    s_nop 1
    v_add_f32_dpp v13, v13, v13 row_ror:8 row_mask:0xf bank_mask:0xf
    v_mov_b32 v15, v13
    s_nop 1
    v_permlane16_swap_b32 v15, v13
    v_add_f32 v13, v13, v15
    v_rcp_f32 v13, v13
    s_nop 0
    v_mul_f32 v12, v12, v13
    v_cvt_pk_bf16_f32 v12, v12, v12
    ds_write_b16 v22, v12
    ds_read_b128 v[12:15], v23
    v_cmp_eq_u32 vcc, 0, v1
    v_cmp_eq_u32 s[38:39], 1, v1
    s_mov_b32 s37, 262144
    s_waitcnt lgkmcnt(0)
    v_cndmask_b32 v32, 0, v12, vcc
    v_cndmask_b32 v36, 0, v12, s[38:39]
    v_cndmask_b32 v33, 0, v13, vcc
    v_cndmask_b32 v37, 0, v13, s[38:39]
    v_cndmask_b32 v34, 0, v14, vcc
    v_cndmask_b32 v38, 0, v14, s[38:39]
    v_cndmask_b32 v35, 0, v15, vcc
    v_cndmask_b32 v39, 0, v15, s[38:39]
L_h3p:
    s_waitcnt vmcnt(0)
    v_bitop3_b32 v8, v160, v164, s56 bitop3:0x7e
    v_bitop3_b32 v9, v168, v172, s56 bitop3:0x7e
    v_bitop3_b32 v10, v161, v165, s57 bitop3:0x7e
    v_bitop3_b32 v11, v169, v173, s57 bitop3:0x7e
    v_bitop3_b32 v12, v162, v166, s58 bitop3:0x7e
    v_bitop3_b32 v13, v170, v174, s58 bitop3:0x7e
    v_bitop3_b32 v14, v163, v167, s59 bitop3:0x7e
    v_bitop3_b32 v15, v171, v175, s59 bitop3:0x7e
    v_or3_b32 v8, v8, v9, v10
    v_or3_b32 v11, v11, v12, v13
    v_or3_b32 v8, v8, v14, v15
    v_or_b32 v8, v8, v11
    v_and_b32 v8, 0x10001, v8
    v_cmp_ne_u32 vcc, 0, v8
    s_cbranch_vccz L_h3pok
    s_sub_u32 s37, s37, 1
    s_cbranch_scc1 L_h3pok
    buffer_load_dwordx4 v[160:163], v3, s[12:15], s49 offen offset:0 sc1
    buffer_load_dwordx4 v[164:167], v4, s[12:15], s49 offen offset:1024 sc1
    buffer_load_dwordx4 v[168:171], v3, s[12:15], s49 offen offset:2048 sc1
    buffer_load_dwordx4 v[172:175], v4, s[12:15], s49 offen offset:3072 sc1
    s_branch L_h3p
L_h3pok:
    v_or_b32 v160, 0x10001, v160
    v_or_b32 v161, 0x10001, v161
    v_or_b32 v162, 0x10001, v162
    v_or_b32 v163, 0x10001, v163
    ds_write_b128 v5, v[160:163] offset:0
    v_or_b32 v164, 0x10001, v164
    v_or_b32 v165, 0x10001, v165
    v_or_b32 v166, 0x10001, v166
    v_or_b32 v167, 0x10001, v167
    ds_write_b128 v5, v[164:167] offset:1024
    v_or_b32 v168, 0x10001, v168
    v_or_b32 v169, 0x10001, v169
    v_or_b32 v170, 0x10001, v170
    v_or_b32 v171, 0x10001, v171
    ds_write_b128 v5, v[168:171] offset:2048
    v_or_b32 v172, 0x10001, v172
    v_or_b32 v173, 0x10001, v173
    v_or_b32 v174, 0x10001, v174
    v_or_b32 v175, 0x10001, v175
    ds_write_b128 v5, v[172:175] offset:3072
    s_waitcnt lgkmcnt(0)
    s_barrier
    ds_read_b64_tr_b16 v[128:129], v24 offset:0
    ds_read_b64_tr_b16 v[130:131], v24 offset:2048
    ds_read_b64_tr_b16 v[132:133], v25 offset:0
    ds_read_b64_tr_b16 v[134:135], v25 offset:2048
    ds_read_b64_tr_b16 v[136:137], v24 offset:32768
    ds_read_b64_tr_b16 v[138:139], v24 offset:34816
    ds_read_b64_tr_b16 v[140:141], v25 offset:32768
    ds_read_b64_tr_b16 v[142:143], v25 offset:34816
    s_waitcnt lgkmcnt(6)
    v_mfma_f32_16x16x32_bf16 v[40:43], v[128:131], v[32:35], 0
    s_waitcnt lgkmcnt(4)
    v_mfma_f32_16x16x32_bf16 v[44:47], v[132:135], v[32:35], 0
    s_waitcnt lgkmcnt(2)
    v_mfma_f32_16x16x32_bf16 v[40:43], v[136:139], v[36:39], v[40:43]
    s_waitcnt lgkmcnt(0)
    v_mfma_f32_16x16x32_bf16 v[44:47], v[140:143], v[36:39], v[44:47]
    s_nop 5
    v_cvt_pk_bf16_f32 v48, v40, v41
    v_cvt_pk_bf16_f32 v49, v42, v43
    v_cvt_pk_bf16_f32 v50, v44, v45
    v_cvt_pk_bf16_f32 v51, v46, v47
    s_mov_b32 exec_lo, 0x30003
    s_mov_b32 exec_hi, 0x30003
    ds_write_b128 v26, v[48:51]
    s_mov_b64 exec, -1
    s_waitcnt lgkmcnt(0)
    s_barrier
    ds_read_b128 v[128:131], v27 offset:0
    ds_read_b128 v[132:135], v27 offset:128
    ds_read_b128 v[136:139], v27 offset:256
    ds_read_b128 v[140:143], v27 offset:384
    ds_read_b128 v[144:147], v27 offset:512
    ds_read_b128 v[148:151], v27 offset:640
    ds_read_b128 v[152:155], v27 offset:768
    ds_read_b128 v[156:159], v27 offset:896
    s_waitcnt lgkmcnt(7)
    v_mfma_f32_16x16x32_bf16 v[40:43], v[64:67], v[128:131], 0
    s_waitcnt lgkmcnt(6)
    v_mfma_f32_16x16x32_bf16 v[40:43], v[68:71], v[132:135], v[40:43]
    s_waitcnt lgkmcnt(5)
    v_mfma_f32_16x16x32_bf16 v[40:43], v[72:75], v[136:139], v[40:43]
    s_waitcnt lgkmcnt(4)
    v_mfma_f32_16x16x32_bf16 v[40:43], v[76:79], v[140:143], v[40:43]
    s_waitcnt lgkmcnt(3)
    v_mfma_f32_16x16x32_bf16 v[40:43], v[80:83], v[144:147], v[40:43]
    s_waitcnt lgkmcnt(2)
    v_mfma_f32_16x16x32_bf16 v[40:43], v[84:87], v[148:151], v[40:43]
    s_waitcnt lgkmcnt(1)
    v_mfma_f32_16x16x32_bf16 v[40:43], v[88:91], v[152:155], v[40:43]
    s_waitcnt lgkmcnt(0)
    v_mfma_f32_16x16x32_bf16 v[40:43], v[92:95], v[156:159], v[40:43]
    s_mov_b32 exec_lo, 0x30003
    s_mov_b32 exec_hi, 0x30003
    s_nop 5
    v_cvt_pk_bf16_f32 v52, v40, v41
    v_cvt_pk_bf16_f32 v53, v42, v43
    buffer_store_dwordx4 v[52:55], v28, s[12:15], s53 offen sc1
    ds_write_b64 v238, v[52:53]
    ds_write_b32 v239, v54
    s_mov_b64 exec, -1
    s_mov_b64 s[58:59], s[60:61]
    s_or_b32 s33, s4, s6
    s_xor_b32 s36, s3, 6
    s_or_b32 s33, s33, s36
    s_cbranch_scc1 L_noep
    s_mov_b64 exec, 1
    buffer_store_dword v253, off, s[12:15], 0 offset:0 sc1
    s_mov_b64 exec, -1
L_noep:
    s_add_u32 m0, s47, 0
    s_nop 0
    buffer_load_dwordx4 v17, s[24:27], s46 offen nt lds
    s_add_u32 s46, s46, 8192
    s_add_u32 m0, s47, 1024
    s_nop 0
    buffer_load_dwordx4 v18, s[24:27], s46 offen nt lds
    s_add_u32 s46, s46, 8192
    s_add_u32 m0, s47, 2048
    s_nop 0
    buffer_load_dwordx4 v17, s[24:27], s46 offen nt lds
    s_add_u32 s46, s46, 8192
    s_add_u32 m0, s47, 3072
    s_nop 0
    buffer_load_dwordx4 v18, s[24:27], s46 offen nt lds
    s_add_u32 s46, s46, 8192
    s_branch L_stageE2
L_end:
    s_endpgm
.section .rodata,"a"
.p2align 6
.amdhsa_kernel concat_heads__sliding_block_cached__compressed_kv_cla__decode_kernel
  .amdhsa_next_free_vgpr 256
  .amdhsa_next_free_sgpr 102
  .amdhsa_accum_offset 256
  .amdhsa_group_segment_fixed_size 0
  .amdhsa_kernarg_size 112
  .amdhsa_user_sgpr_count 2
  .amdhsa_user_sgpr_kernarg_segment_ptr 1
  .amdhsa_system_sgpr_workgroup_id_x 1
  .amdhsa_float_denorm_mode_32 3
.end_amdhsa_kernel
```
